```python
import torch

def _softmax(x, axis=-1):
    return torch.softmax(x, dim=axis)
def _gelu(x):
    return torch.nn.functional.gelu(x, approximate="tanh")
def _silu(x):
    return torch.nn.functional.silu(x)
def _sigmoid(x):
    return torch.sigmoid(x)
def _layernorm(x, axis=-1, eps=1e-5):
    m = x.mean(dim=axis, keepdim=True)
    v = x.var(dim=axis, keepdim=True, unbiased=False)
    return (x - m) / torch.sqrt(v + eps)
def _scatter_add(tgt, idx, src, axis=0):
    return tgt.clone().index_add_(axis, idx, src)
def _segment_sum(src, seg, n):
    out = torch.zeros((n,) + src.shape[1:], dtype=src.dtype)
    return out.index_add_(0, seg, src)
def _pad(x, pw):
    flat = tuple(v for pair in reversed(pw) for v in pair)
    return torch.nn.functional.pad(x, flat)

kernel_name = 'standalone__linear_attn_block__prompt'

def setup_inputs():

    _w = (lambda a: (lambda t: t.to(torch.bfloat16) if t.is_floating_point() else t)(torch.as_tensor(a)))
    B, S, D = 1, 2048, 640
    return {
        "x": _w((lambda *s: torch.randn(*s, dtype=torch.bfloat16) * 0.05)(B, S, D)),
        "wqkv": _w((lambda *s: torch.randn(*s, dtype=torch.bfloat16) * 0.4)(D, 3 * D)),
        "wo": _w((lambda *s: torch.randn(*s, dtype=torch.bfloat16) * 0.05)(D, D)),
    }

def reference(x, wqkv, wo):
    B, S, D = x.shape
    H = 32; Dh = D // H
    qkv = (lambda x, *d: x.permute(*d))((x @ wqkv).reshape(B, S, 3, H, Dh), 2, 0, 3, 1, 4)
    q, k, v = qkv[0], qkv[1], qkv[2]
    phi = lambda t: torch.where(t > 0, t + 1, torch.exp(t)) + 1e-6
    pq, pk = phi(q), phi(k)
    kv = torch.einsum("bhsd,bhse->bhde", pk, v)
    z = torch.einsum("bhsd->bhd", pk)
    num = torch.einsum("bhqd,bhde->bhqe", pq, kv)
    den = torch.einsum("bhqd,bhd->bhq", pq, z)[..., None] + 1e-6
    o = num / den
    return (lambda x, *d: x.permute(*d))(o, 0, 2, 1, 3).reshape(B, S, D) @ wo
```

```asm
; @launch kernel=standalone__linear_attn_block__prompt_kernel grid=(192,1,1) block=(512,1,1) lds=147456
; @launch kernel=linear_attn_out_kernel grid=(256,1,1) block=(512,1,1) lds=163840
.amdgcn_target "amdgcn-amd-amdhsa--gfx950"
.text
.globl standalone__linear_attn_block__prompt_kernel
.p2align 8
.type standalone__linear_attn_block__prompt_kernel,@function
standalone__linear_attn_block__prompt_kernel:
    s_cmp_ge_u32 s2, 192
    s_cbranch_scc1 K1_END
    s_load_dwordx4 s[4:7], s[0:1], 0
    s_load_dwordx4 s[24:27], s[0:1], 32
    v_and_b32 v1, 63, v0
    v_lshrrev_b32 v2, 6, v0
    s_nop 0
    v_readfirstlane_b32 s28, v2
    s_waitcnt lgkmcnt(0)
    s_and_b32 s33, s2, 7
    s_lshr_b32 s34, s2, 3
    s_and_b32 s29, s33, 1
    s_lshl_b32 s29, s29, 3
    s_and_b32 s35, s34, 7
    s_add_u32 s29, s29, s35
    s_lshr_b32 s34, s34, 3
    s_lshr_b32 s33, s33, 1
    s_cmp_eq_u32 s34, 2
    s_cselect_b32 s48, 1, 0
    s_cbranch_scc1 K1_DEC_Q
    s_lshl_b32 s30, s33, 1
    s_add_u32 s30, s30, s34
    s_mul_i32 s31, s30, 160
    s_add_u32 s31, s31, 1280
    s_mov_b32 s32, 1120
    s_branch K1_DEC_DONE
K1_DEC_Q:
    s_mov_b32 s30, s33
    s_mul_i32 s31, s30, 320
    s_mov_b32 s32, 0
K1_DEC_DONE:
    s_add_u32 s20, s26, 0x300000
    s_addc_u32 s21, s27, 0
    s_mov_b32 s22, 0xd200
    s_mov_b32 s23, 0x00020000
    s_cmp_lt_u32 s28, 4
    s_cbranch_scc1 K1_COMPUTE
    s_mov_b32 s8, s4
    s_mov_b32 s9, s5
    s_mov_b32 s10, 0x280000
    s_mov_b32 s11, 0x00020000
    s_mov_b32 s12, s6
    s_mov_b32 s13, s7
    s_mov_b32 s14, 0x258000
    s_mov_b32 s15, 0x00020000
    s_sub_u32 s28, s28, 4
    s_lshl_b32 s33, s28, 6
    v_add_u32 v9, s33, v1
    s_movk_i32 s34, 3277
    v_add_u32 v10, 0, v9
    v_mul_u32_u24 v11, s34, v10
    v_lshrrev_b32 v11, 16, v11
    v_mul_u32_u24 v12, 20, v11
    v_sub_u32 v12, v10, v12
    v_mul_u32_u24 v13, 3840, v11
    v_lshl_add_u32 v13, v12, 4, v13
    v_add_u32 v13, s31, v13
    v_cmp_lt_u32 vcc, 9, v12
    v_mov_b32 v14, s32
    s_nop 1
    v_cndmask_b32 v14, 0, v14, vcc
    v_add_u32 v2, v13, v14
    v_add_u32 v10, 256, v9
    v_mul_u32_u24 v11, s34, v10
    v_lshrrev_b32 v11, 16, v11
    v_mul_u32_u24 v12, 20, v11
    v_sub_u32 v12, v10, v12
    v_mul_u32_u24 v13, 3840, v11
    v_lshl_add_u32 v13, v12, 4, v13
    v_add_u32 v13, s31, v13
    v_cmp_lt_u32 vcc, 9, v12
    v_mov_b32 v14, s32
    s_nop 1
    v_cndmask_b32 v14, 0, v14, vcc
    v_add_u32 v3, v13, v14
    v_add_u32 v10, 512, v9
    v_mul_u32_u24 v11, s34, v10
    v_lshrrev_b32 v11, 16, v11
    v_mul_u32_u24 v12, 20, v11
    v_sub_u32 v12, v10, v12
    v_mul_u32_u24 v13, 3840, v11
    v_lshl_add_u32 v13, v12, 4, v13
    v_add_u32 v13, s31, v13
    v_cmp_lt_u32 vcc, 9, v12
    v_mov_b32 v14, s32
    s_nop 1
    v_cndmask_b32 v14, 0, v14, vcc
    v_add_u32 v4, v13, v14
    v_add_u32 v10, 768, v9
    v_mul_u32_u24 v11, s34, v10
    v_lshrrev_b32 v11, 16, v11
    v_mul_u32_u24 v12, 20, v11
    v_sub_u32 v12, v10, v12
    v_mul_u32_u24 v13, 3840, v11
    v_lshl_add_u32 v13, v12, 4, v13
    v_add_u32 v13, s31, v13
    v_cmp_lt_u32 vcc, 9, v12
    v_mov_b32 v14, s32
    s_nop 1
    v_cndmask_b32 v14, 0, v14, vcc
    v_add_u32 v5, v13, v14
    v_add_u32 v10, 1024, v9
    v_mul_u32_u24 v11, s34, v10
    v_lshrrev_b32 v11, 16, v11
    v_mul_u32_u24 v12, 20, v11
    v_sub_u32 v12, v10, v12
    v_mul_u32_u24 v13, 3840, v11
    v_lshl_add_u32 v13, v12, 4, v13
    v_add_u32 v13, s31, v13
    v_cmp_lt_u32 vcc, 9, v12
    v_mov_b32 v14, s32
    s_nop 1
    v_cndmask_b32 v14, 0, v14, vcc
    v_add_u32 v6, v13, v14
    s_lshl_b32 s33, s29, 7
    s_lshl_b32 s34, s28, 5
    s_add_u32 s33, s33, s34
    v_lshrrev_b32 v10, 3, v1
    v_add_u32 v10, s33, v10
    v_mul_u32_u24 v10, 1280, v10
    v_lshrrev_b32 v11, 4, v1
    v_and_b32 v12, 7, v1
    v_xor_b32 v12, v12, v11
    v_lshl_add_u32 v7, v12, 4, v10
    v_xor_b32 v12, 4, v12
    v_lshl_add_u32 v8, v12, 4, v10
    s_lshl_b32 s35, s28, 10
    s_lshl_b32 s37, s28, 12
    s_mov_b32 s43, 0
    s_add_u32 m0, s35, 0
    s_nop 0
    buffer_load_dwordx4 v2, s[12:15], s43 offen lds
    s_add_u32 m0, s35, 4096
    s_nop 0
    buffer_load_dwordx4 v3, s[12:15], s43 offen lds
    s_add_u32 m0, s35, 8192
    s_nop 0
    buffer_load_dwordx4 v4, s[12:15], s43 offen lds
    s_add_u32 m0, s35, 12288
    s_nop 0
    buffer_load_dwordx4 v5, s[12:15], s43 offen lds
    s_add_u32 m0, s35, 16384
    s_nop 0
    buffer_load_dwordx4 v6, s[12:15], s43 offen lds
    s_add_u32 m0, s37, 20480
    s_mov_b32 s46, 0
    buffer_load_dwordx4 v7, s[8:11], s46 offen lds
    s_add_u32 m0, s37, 21504
    s_mov_b32 s46, 10240
    buffer_load_dwordx4 v8, s[8:11], s46 offen lds
    s_add_u32 m0, s37, 22528
    s_mov_b32 s46, 20480
    buffer_load_dwordx4 v7, s[8:11], s46 offen lds
    s_add_u32 m0, s37, 23552
    s_mov_b32 s46, 30720
    buffer_load_dwordx4 v8, s[8:11], s46 offen lds
    s_mov_b32 s43, 245760
    s_add_u32 m0, s35, 36864
    s_nop 0
    buffer_load_dwordx4 v2, s[12:15], s43 offen lds
    s_add_u32 m0, s35, 40960
    s_nop 0
    buffer_load_dwordx4 v3, s[12:15], s43 offen lds
    s_add_u32 m0, s35, 45056
    s_nop 0
    buffer_load_dwordx4 v4, s[12:15], s43 offen lds
    s_add_u32 m0, s35, 49152
    s_nop 0
    buffer_load_dwordx4 v5, s[12:15], s43 offen lds
    s_add_u32 m0, s35, 53248
    s_nop 0
    buffer_load_dwordx4 v6, s[12:15], s43 offen lds
    s_add_u32 m0, s37, 57344
    s_mov_b32 s46, 128
    buffer_load_dwordx4 v7, s[8:11], s46 offen lds
    s_add_u32 m0, s37, 58368
    s_mov_b32 s46, 10368
    buffer_load_dwordx4 v8, s[8:11], s46 offen lds
    s_add_u32 m0, s37, 59392
    s_mov_b32 s46, 20608
    buffer_load_dwordx4 v7, s[8:11], s46 offen lds
    s_add_u32 m0, s37, 60416
    s_mov_b32 s46, 30848
    buffer_load_dwordx4 v8, s[8:11], s46 offen lds
    s_mov_b32 s43, 491520
    s_add_u32 m0, s35, 73728
    s_nop 0
    buffer_load_dwordx4 v2, s[12:15], s43 offen lds
    s_add_u32 m0, s35, 77824
    s_nop 0
    buffer_load_dwordx4 v3, s[12:15], s43 offen lds
    s_add_u32 m0, s35, 81920
    s_nop 0
    buffer_load_dwordx4 v4, s[12:15], s43 offen lds
    s_add_u32 m0, s35, 86016
    s_nop 0
    buffer_load_dwordx4 v5, s[12:15], s43 offen lds
    s_add_u32 m0, s35, 90112
    s_nop 0
    buffer_load_dwordx4 v6, s[12:15], s43 offen lds
    s_add_u32 m0, s37, 94208
    s_mov_b32 s46, 256
    buffer_load_dwordx4 v7, s[8:11], s46 offen lds
    s_add_u32 m0, s37, 95232
    s_mov_b32 s46, 10496
    buffer_load_dwordx4 v8, s[8:11], s46 offen lds
    s_add_u32 m0, s37, 96256
    s_mov_b32 s46, 20736
    buffer_load_dwordx4 v7, s[8:11], s46 offen lds
    s_add_u32 m0, s37, 97280
    s_mov_b32 s46, 30976
    buffer_load_dwordx4 v8, s[8:11], s46 offen lds
    s_or_b32 s33, s29, s48
    s_cmp_lg_u32 s33, 0
    s_cbranch_scc1 K1_NOZERO
    v_mov_b32 v16, 0
    v_mov_b32 v17, 0
    v_mov_b32 v18, 0
    v_mov_b32 v19, 0
    v_and_b32 v21, 255, v0
    s_mul_i32 s33, s30, 6400
    v_lshlrev_b32 v20, 4, v21
    buffer_store_dwordx4 v[16:19], v20, s[20:23], s33 offen sc0 sc1
    s_add_u32 s33, s33, 4096
    v_cmp_gt_u32 vcc, 144, v21
    s_and_saveexec_b64 s[40:41], vcc
    buffer_store_dwordx4 v[16:19], v20, s[20:23], s33 offen sc0 sc1
    s_mul_i32 s33, s30, 320
    s_add_u32 s33, s33, 51200
    v_cmp_gt_u32 vcc, 20, v21
    s_and_b64 exec, exec, vcc
    buffer_store_dwordx4 v[16:19], v20, s[20:23], s33 offen sc0 sc1
    s_mov_b64 exec, s[40:41]
    s_waitcnt vmcnt(0)
    v_mov_b32 v16, 1
    v_mov_b32 v17, 0
    s_lshl_b32 s33, s30, 2
    s_add_u32 s38, s24, s33
    s_addc_u32 s39, s25, 0
    v_cmp_eq_u32 vcc, 0, v1
    s_and_saveexec_b64 s[40:41], vcc
    global_atomic_add v17, v16, s[38:39] sc1
    s_mov_b64 exec, s[40:41]
    s_waitcnt vmcnt(0)
K1_NOZERO:
    s_waitcnt vmcnt(9)
    s_barrier
    s_waitcnt vmcnt(9)
    s_barrier
    s_mov_b32 s43, 737280
    s_add_u32 m0, s35, 110592
    s_nop 0
    buffer_load_dwordx4 v2, s[12:15], s43 offen lds
    s_add_u32 m0, s35, 114688
    s_nop 0
    buffer_load_dwordx4 v3, s[12:15], s43 offen lds
    s_add_u32 m0, s35, 118784
    s_nop 0
    buffer_load_dwordx4 v4, s[12:15], s43 offen lds
    s_add_u32 m0, s35, 122880
    s_nop 0
    buffer_load_dwordx4 v5, s[12:15], s43 offen lds
    s_add_u32 m0, s35, 126976
    s_nop 0
    buffer_load_dwordx4 v6, s[12:15], s43 offen lds
    s_add_u32 m0, s37, 131072
    s_mov_b32 s46, 384
    buffer_load_dwordx4 v7, s[8:11], s46 offen lds
    s_add_u32 m0, s37, 132096
    s_mov_b32 s46, 10624
    buffer_load_dwordx4 v8, s[8:11], s46 offen lds
    s_add_u32 m0, s37, 133120
    s_mov_b32 s46, 20864
    buffer_load_dwordx4 v7, s[8:11], s46 offen lds
    s_add_u32 m0, s37, 134144
    s_mov_b32 s46, 31104
    buffer_load_dwordx4 v8, s[8:11], s46 offen lds
    s_waitcnt vmcnt(9)
    s_barrier
    s_mov_b32 s43, 983040
    s_add_u32 m0, s35, 0
    s_nop 0
    buffer_load_dwordx4 v2, s[12:15], s43 offen lds
    s_add_u32 m0, s35, 4096
    s_nop 0
    buffer_load_dwordx4 v3, s[12:15], s43 offen lds
    s_add_u32 m0, s35, 8192
    s_nop 0
    buffer_load_dwordx4 v4, s[12:15], s43 offen lds
    s_add_u32 m0, s35, 12288
    s_nop 0
    buffer_load_dwordx4 v5, s[12:15], s43 offen lds
    s_add_u32 m0, s35, 16384
    s_nop 0
    buffer_load_dwordx4 v6, s[12:15], s43 offen lds
    s_add_u32 m0, s37, 20480
    s_mov_b32 s46, 512
    buffer_load_dwordx4 v7, s[8:11], s46 offen lds
    s_add_u32 m0, s37, 21504
    s_mov_b32 s46, 10752
    buffer_load_dwordx4 v8, s[8:11], s46 offen lds
    s_add_u32 m0, s37, 22528
    s_mov_b32 s46, 20992
    buffer_load_dwordx4 v7, s[8:11], s46 offen lds
    s_add_u32 m0, s37, 23552
    s_mov_b32 s46, 31232
    buffer_load_dwordx4 v8, s[8:11], s46 offen lds
    s_waitcnt vmcnt(9)
    s_barrier
    s_mov_b32 s43, 1228800
    s_add_u32 m0, s35, 36864
    s_nop 0
    buffer_load_dwordx4 v2, s[12:15], s43 offen lds
    s_add_u32 m0, s35, 40960
    s_nop 0
    buffer_load_dwordx4 v3, s[12:15], s43 offen lds
    s_add_u32 m0, s35, 45056
    s_nop 0
    buffer_load_dwordx4 v4, s[12:15], s43 offen lds
    s_add_u32 m0, s35, 49152
    s_nop 0
    buffer_load_dwordx4 v5, s[12:15], s43 offen lds
    s_add_u32 m0, s35, 53248
    s_nop 0
    buffer_load_dwordx4 v6, s[12:15], s43 offen lds
    s_add_u32 m0, s37, 57344
    s_mov_b32 s46, 640
    buffer_load_dwordx4 v7, s[8:11], s46 offen lds
    s_add_u32 m0, s37, 58368
    s_mov_b32 s46, 10880
    buffer_load_dwordx4 v8, s[8:11], s46 offen lds
    s_add_u32 m0, s37, 59392
    s_mov_b32 s46, 21120
    buffer_load_dwordx4 v7, s[8:11], s46 offen lds
    s_add_u32 m0, s37, 60416
    s_mov_b32 s46, 31360
    buffer_load_dwordx4 v8, s[8:11], s46 offen lds
    s_waitcnt vmcnt(9)
    s_barrier
    s_mov_b32 s43, 1474560
    s_add_u32 m0, s35, 73728
    s_nop 0
    buffer_load_dwordx4 v2, s[12:15], s43 offen lds
    s_add_u32 m0, s35, 77824
    s_nop 0
    buffer_load_dwordx4 v3, s[12:15], s43 offen lds
    s_add_u32 m0, s35, 81920
    s_nop 0
    buffer_load_dwordx4 v4, s[12:15], s43 offen lds
    s_add_u32 m0, s35, 86016
    s_nop 0
    buffer_load_dwordx4 v5, s[12:15], s43 offen lds
    s_add_u32 m0, s35, 90112
    s_nop 0
    buffer_load_dwordx4 v6, s[12:15], s43 offen lds
    s_add_u32 m0, s37, 94208
    s_mov_b32 s46, 768
    buffer_load_dwordx4 v7, s[8:11], s46 offen lds
    s_add_u32 m0, s37, 95232
    s_mov_b32 s46, 11008
    buffer_load_dwordx4 v8, s[8:11], s46 offen lds
    s_add_u32 m0, s37, 96256
    s_mov_b32 s46, 21248
    buffer_load_dwordx4 v7, s[8:11], s46 offen lds
    s_add_u32 m0, s37, 97280
    s_mov_b32 s46, 31488
    buffer_load_dwordx4 v8, s[8:11], s46 offen lds
    s_waitcnt vmcnt(9)
    s_barrier
    s_mov_b32 s43, 1720320
    s_add_u32 m0, s35, 110592
    s_nop 0
    buffer_load_dwordx4 v2, s[12:15], s43 offen lds
    s_add_u32 m0, s35, 114688
    s_nop 0
    buffer_load_dwordx4 v3, s[12:15], s43 offen lds
    s_add_u32 m0, s35, 118784
    s_nop 0
    buffer_load_dwordx4 v4, s[12:15], s43 offen lds
    s_add_u32 m0, s35, 122880
    s_nop 0
    buffer_load_dwordx4 v5, s[12:15], s43 offen lds
    s_add_u32 m0, s35, 126976
    s_nop 0
    buffer_load_dwordx4 v6, s[12:15], s43 offen lds
    s_add_u32 m0, s37, 131072
    s_mov_b32 s46, 896
    buffer_load_dwordx4 v7, s[8:11], s46 offen lds
    s_add_u32 m0, s37, 132096
    s_mov_b32 s46, 11136
    buffer_load_dwordx4 v8, s[8:11], s46 offen lds
    s_add_u32 m0, s37, 133120
    s_mov_b32 s46, 21376
    buffer_load_dwordx4 v7, s[8:11], s46 offen lds
    s_add_u32 m0, s37, 134144
    s_mov_b32 s46, 31616
    buffer_load_dwordx4 v8, s[8:11], s46 offen lds
    s_waitcnt vmcnt(9)
    s_barrier
    s_mov_b32 s43, 1966080
    s_add_u32 m0, s35, 0
    s_nop 0
    buffer_load_dwordx4 v2, s[12:15], s43 offen lds
    s_add_u32 m0, s35, 4096
    s_nop 0
    buffer_load_dwordx4 v3, s[12:15], s43 offen lds
    s_add_u32 m0, s35, 8192
    s_nop 0
    buffer_load_dwordx4 v4, s[12:15], s43 offen lds
    s_add_u32 m0, s35, 12288
    s_nop 0
    buffer_load_dwordx4 v5, s[12:15], s43 offen lds
    s_add_u32 m0, s35, 16384
    s_nop 0
    buffer_load_dwordx4 v6, s[12:15], s43 offen lds
    s_add_u32 m0, s37, 20480
    s_mov_b32 s46, 1024
    buffer_load_dwordx4 v7, s[8:11], s46 offen lds
    s_add_u32 m0, s37, 21504
    s_mov_b32 s46, 11264
    buffer_load_dwordx4 v8, s[8:11], s46 offen lds
    s_add_u32 m0, s37, 22528
    s_mov_b32 s46, 21504
    buffer_load_dwordx4 v7, s[8:11], s46 offen lds
    s_add_u32 m0, s37, 23552
    s_mov_b32 s46, 31744
    buffer_load_dwordx4 v8, s[8:11], s46 offen lds
    s_waitcnt vmcnt(9)
    s_barrier
    s_mov_b32 s43, 2211840
    s_add_u32 m0, s35, 36864
    s_nop 0
    buffer_load_dwordx4 v2, s[12:15], s43 offen lds
    s_add_u32 m0, s35, 40960
    s_nop 0
    buffer_load_dwordx4 v3, s[12:15], s43 offen lds
    s_add_u32 m0, s35, 45056
    s_nop 0
    buffer_load_dwordx4 v4, s[12:15], s43 offen lds
    s_add_u32 m0, s35, 49152
    s_nop 0
    buffer_load_dwordx4 v5, s[12:15], s43 offen lds
    s_add_u32 m0, s35, 53248
    s_nop 0
    buffer_load_dwordx4 v6, s[12:15], s43 offen lds
    s_add_u32 m0, s37, 57344
    s_mov_b32 s46, 1152
    buffer_load_dwordx4 v7, s[8:11], s46 offen lds
    s_add_u32 m0, s37, 58368
    s_mov_b32 s46, 11392
    buffer_load_dwordx4 v8, s[8:11], s46 offen lds
    s_add_u32 m0, s37, 59392
    s_mov_b32 s46, 21632
    buffer_load_dwordx4 v7, s[8:11], s46 offen lds
    s_add_u32 m0, s37, 60416
    s_mov_b32 s46, 31872
    buffer_load_dwordx4 v8, s[8:11], s46 offen lds
    s_waitcnt vmcnt(9)
    s_barrier
    s_waitcnt vmcnt(0)
    s_barrier
    s_waitcnt vmcnt(0)
    s_barrier
    s_endpgm
K1_COMPUTE:
    s_mov_b32 s16, s26
    s_mov_b32 s17, s27
    s_mov_b32 s18, 0x280000
    s_mov_b32 s19, 0x00020000
    v_lshrrev_b32 v11, 5, v1
    v_lshlrev_b32 v12, 5, v11
    v_bfe_u32 v13, v1, 2, 2
    v_add_u32 v12, v12, v13
    v_mul_u32_u24 v8, 320, v12
    v_bfe_u32 v13, v1, 4, 1
    v_lshl_add_u32 v8, v13, 5, v8
    v_and_b32 v13, 3, v1
    v_lshl_add_u32 v8, v13, 3, v8
    v_and_b32 v10, 31, v1
    s_lshl_b32 s33, s28, 5
    v_add_u32 v12, s33, v10
    v_lshlrev_b32 v12, 7, v12
    v_add_u32 v12, 20480, v12
    v_bfe_u32 v13, v1, 1, 3
    v_lshlrev_b32 v14, 2, v11
    v_xor_b32 v13, v13, v14
    v_xor_b32 v14, 0, v13
    v_lshl_add_u32 v2, v14, 4, v12
    v_xor_b32 v14, 1, v13
    v_lshl_add_u32 v3, v14, 4, v12
    v_xor_b32 v14, 2, v13
    v_lshl_add_u32 v4, v14, 4, v12
    v_xor_b32 v14, 3, v13
    v_lshl_add_u32 v5, v14, 4, v12
    v_accvgpr_write_b32 a0, 0
    v_accvgpr_write_b32 a1, 0
    v_accvgpr_write_b32 a2, 0
    v_accvgpr_write_b32 a3, 0
    v_accvgpr_write_b32 a4, 0
    v_accvgpr_write_b32 a5, 0
    v_accvgpr_write_b32 a6, 0
    v_accvgpr_write_b32 a7, 0
    v_accvgpr_write_b32 a8, 0
    v_accvgpr_write_b32 a9, 0
    v_accvgpr_write_b32 a10, 0
    v_accvgpr_write_b32 a11, 0
    v_accvgpr_write_b32 a12, 0
    v_accvgpr_write_b32 a13, 0
    v_accvgpr_write_b32 a14, 0
    v_accvgpr_write_b32 a15, 0
    v_accvgpr_write_b32 a16, 0
    v_accvgpr_write_b32 a17, 0
    v_accvgpr_write_b32 a18, 0
    v_accvgpr_write_b32 a19, 0
    v_accvgpr_write_b32 a20, 0
    v_accvgpr_write_b32 a21, 0
    v_accvgpr_write_b32 a22, 0
    v_accvgpr_write_b32 a23, 0
    v_accvgpr_write_b32 a24, 0
    v_accvgpr_write_b32 a25, 0
    v_accvgpr_write_b32 a26, 0
    v_accvgpr_write_b32 a27, 0
    v_accvgpr_write_b32 a28, 0
    v_accvgpr_write_b32 a29, 0
    v_accvgpr_write_b32 a30, 0
    v_accvgpr_write_b32 a31, 0
    v_accvgpr_write_b32 a32, 0
    v_accvgpr_write_b32 a33, 0
    v_accvgpr_write_b32 a34, 0
    v_accvgpr_write_b32 a35, 0
    v_accvgpr_write_b32 a36, 0
    v_accvgpr_write_b32 a37, 0
    v_accvgpr_write_b32 a38, 0
    v_accvgpr_write_b32 a39, 0
    v_accvgpr_write_b32 a40, 0
    v_accvgpr_write_b32 a41, 0
    v_accvgpr_write_b32 a42, 0
    v_accvgpr_write_b32 a43, 0
    v_accvgpr_write_b32 a44, 0
    v_accvgpr_write_b32 a45, 0
    v_accvgpr_write_b32 a46, 0
    v_accvgpr_write_b32 a47, 0
    v_accvgpr_write_b32 a48, 0
    v_accvgpr_write_b32 a49, 0
    v_accvgpr_write_b32 a50, 0
    v_accvgpr_write_b32 a51, 0
    v_accvgpr_write_b32 a52, 0
    v_accvgpr_write_b32 a53, 0
    v_accvgpr_write_b32 a54, 0
    v_accvgpr_write_b32 a55, 0
    v_accvgpr_write_b32 a56, 0
    v_accvgpr_write_b32 a57, 0
    v_accvgpr_write_b32 a58, 0
    v_accvgpr_write_b32 a59, 0
    v_accvgpr_write_b32 a60, 0
    v_accvgpr_write_b32 a61, 0
    v_accvgpr_write_b32 a62, 0
    v_accvgpr_write_b32 a63, 0
    v_accvgpr_write_b32 a64, 0
    v_accvgpr_write_b32 a65, 0
    v_accvgpr_write_b32 a66, 0
    v_accvgpr_write_b32 a67, 0
    v_accvgpr_write_b32 a68, 0
    v_accvgpr_write_b32 a69, 0
    v_accvgpr_write_b32 a70, 0
    v_accvgpr_write_b32 a71, 0
    v_accvgpr_write_b32 a72, 0
    v_accvgpr_write_b32 a73, 0
    v_accvgpr_write_b32 a74, 0
    v_accvgpr_write_b32 a75, 0
    v_accvgpr_write_b32 a76, 0
    v_accvgpr_write_b32 a77, 0
    v_accvgpr_write_b32 a78, 0
    v_accvgpr_write_b32 a79, 0
    s_mov_b32 s40, 0
    s_mov_b32 s42, 0
    s_cmp_lg_u32 s48, 0
    s_cbranch_scc1 K1_QLOOP
    s_barrier
    ds_read_b128 v[96:99], v2
    ds_read_b64_tr_b16 v[16:17], v8 offset:0
    ds_read_b64_tr_b16 v[18:19], v8 offset:1280
    ds_read_b64_tr_b16 v[20:21], v8 offset:64
    ds_read_b64_tr_b16 v[22:23], v8 offset:1344
    ds_read_b64_tr_b16 v[24:25], v8 offset:128
    ds_read_b64_tr_b16 v[26:27], v8 offset:1408
    ds_read_b64_tr_b16 v[28:29], v8 offset:192
    ds_read_b64_tr_b16 v[30:31], v8 offset:1472
    ds_read_b64_tr_b16 v[32:33], v8 offset:256
    ds_read_b64_tr_b16 v[34:35], v8 offset:1536
    ds_read_b128 v[100:103], v3
    ds_read_b64_tr_b16 v[36:37], v8 offset:2560
    ds_read_b64_tr_b16 v[38:39], v8 offset:3840
    ds_read_b64_tr_b16 v[40:41], v8 offset:2624
    ds_read_b64_tr_b16 v[42:43], v8 offset:3904
    ds_read_b64_tr_b16 v[44:45], v8 offset:2688
    ds_read_b64_tr_b16 v[46:47], v8 offset:3968
    ds_read_b64_tr_b16 v[48:49], v8 offset:2752
    ds_read_b64_tr_b16 v[50:51], v8 offset:4032
    ds_read_b64_tr_b16 v[52:53], v8 offset:2816
    ds_read_b64_tr_b16 v[54:55], v8 offset:4096
    s_mov_b32 s41, 36864
K1_LOOP_KV:
    v_add_u32 v112, s40, v8
    v_add_u32 v115, s40, v4
    v_add_u32 v116, s40, v5
    v_add_u32 v117, s41, v8
    v_add_u32 v118, s41, v2
    v_add_u32 v119, s41, v3
    s_barrier
    s_waitcnt lgkmcnt(11)
    ds_read_b128 v[104:107], v115
    ds_read_b64_tr_b16 v[56:57], v112 offset:5120
    ds_read_b64_tr_b16 v[58:59], v112 offset:6400
    ds_read_b64_tr_b16 v[60:61], v112 offset:5184
    ds_read_b64_tr_b16 v[62:63], v112 offset:6464
    ds_read_b64_tr_b16 v[64:65], v112 offset:5248
    ds_read_b64_tr_b16 v[66:67], v112 offset:6528
    ds_read_b64_tr_b16 v[68:69], v112 offset:5312
    ds_read_b64_tr_b16 v[70:71], v112 offset:6592
    ds_read_b64_tr_b16 v[72:73], v112 offset:5376
    ds_read_b64_tr_b16 v[74:75], v112 offset:6656
    v_mfma_f32_32x32x16_bf16 a[0:15], v[96:99], v[16:19], a[0:15]
    v_mfma_f32_32x32x16_bf16 a[16:31], v[96:99], v[20:23], a[16:31]
    v_mfma_f32_32x32x16_bf16 a[32:47], v[96:99], v[24:27], a[32:47]
    v_mfma_f32_32x32x16_bf16 a[48:63], v[96:99], v[28:31], a[48:63]
    v_mfma_f32_32x32x16_bf16 a[64:79], v[96:99], v[32:35], a[64:79]
    s_waitcnt lgkmcnt(11)
    ds_read_b128 v[108:111], v116
    ds_read_b64_tr_b16 v[76:77], v112 offset:7680
    ds_read_b64_tr_b16 v[78:79], v112 offset:8960
    ds_read_b64_tr_b16 v[80:81], v112 offset:7744
    ds_read_b64_tr_b16 v[82:83], v112 offset:9024
    ds_read_b64_tr_b16 v[84:85], v112 offset:7808
    ds_read_b64_tr_b16 v[86:87], v112 offset:9088
    ds_read_b64_tr_b16 v[88:89], v112 offset:7872
    ds_read_b64_tr_b16 v[90:91], v112 offset:9152
    ds_read_b64_tr_b16 v[92:93], v112 offset:7936
    ds_read_b64_tr_b16 v[94:95], v112 offset:9216
    v_mfma_f32_32x32x16_bf16 a[0:15], v[100:103], v[36:39], a[0:15]
    v_mfma_f32_32x32x16_bf16 a[16:31], v[100:103], v[40:43], a[16:31]
    v_mfma_f32_32x32x16_bf16 a[32:47], v[100:103], v[44:47], a[32:47]
    v_mfma_f32_32x32x16_bf16 a[48:63], v[100:103], v[48:51], a[48:63]
    v_mfma_f32_32x32x16_bf16 a[64:79], v[100:103], v[52:55], a[64:79]
    s_waitcnt lgkmcnt(11)
    ds_read_b128 v[96:99], v118
    ds_read_b64_tr_b16 v[16:17], v117 offset:0
    ds_read_b64_tr_b16 v[18:19], v117 offset:1280
    ds_read_b64_tr_b16 v[20:21], v117 offset:64
    ds_read_b64_tr_b16 v[22:23], v117 offset:1344
    ds_read_b64_tr_b16 v[24:25], v117 offset:128
    ds_read_b64_tr_b16 v[26:27], v117 offset:1408
    ds_read_b64_tr_b16 v[28:29], v117 offset:192
    ds_read_b64_tr_b16 v[30:31], v117 offset:1472
    ds_read_b64_tr_b16 v[32:33], v117 offset:256
    ds_read_b64_tr_b16 v[34:35], v117 offset:1536
    v_mfma_f32_32x32x16_bf16 a[0:15], v[104:107], v[56:59], a[0:15]
    v_mfma_f32_32x32x16_bf16 a[16:31], v[104:107], v[60:63], a[16:31]
    v_mfma_f32_32x32x16_bf16 a[32:47], v[104:107], v[64:67], a[32:47]
    v_mfma_f32_32x32x16_bf16 a[48:63], v[104:107], v[68:71], a[48:63]
    v_mfma_f32_32x32x16_bf16 a[64:79], v[104:107], v[72:75], a[64:79]
    s_waitcnt lgkmcnt(11)
    ds_read_b128 v[100:103], v119
    ds_read_b64_tr_b16 v[36:37], v117 offset:2560
    ds_read_b64_tr_b16 v[38:39], v117 offset:3840
    ds_read_b64_tr_b16 v[40:41], v117 offset:2624
    ds_read_b64_tr_b16 v[42:43], v117 offset:3904
    ds_read_b64_tr_b16 v[44:45], v117 offset:2688
    ds_read_b64_tr_b16 v[46:47], v117 offset:3968
    ds_read_b64_tr_b16 v[48:49], v117 offset:2752
    ds_read_b64_tr_b16 v[50:51], v117 offset:4032
    ds_read_b64_tr_b16 v[52:53], v117 offset:2816
    ds_read_b64_tr_b16 v[54:55], v117 offset:4096
    v_mfma_f32_32x32x16_bf16 a[0:15], v[108:111], v[76:79], a[0:15]
    v_mfma_f32_32x32x16_bf16 a[16:31], v[108:111], v[80:83], a[16:31]
    v_mfma_f32_32x32x16_bf16 a[32:47], v[108:111], v[84:87], a[32:47]
    v_mfma_f32_32x32x16_bf16 a[48:63], v[108:111], v[88:91], a[48:63]
    v_mfma_f32_32x32x16_bf16 a[64:79], v[108:111], v[92:95], a[64:79]
    s_mov_b32 s40, s41
    s_add_u32 s41, s41, 36864
    s_cmp_eq_u32 s41, 147456
    s_cselect_b32 s41, 0, s41
    s_add_u32 s42, s42, 1
    s_cmp_lt_u32 s42, 10
    s_cbranch_scc1 K1_LOOP_KV
    s_waitcnt lgkmcnt(0)
    s_nop 15
    v_accvgpr_read_b32 v16, a0
    v_accvgpr_read_b32 v17, a1
    v_accvgpr_read_b32 v18, a2
    v_accvgpr_read_b32 v19, a3
    v_accvgpr_read_b32 v20, a4
    v_accvgpr_read_b32 v21, a5
    v_accvgpr_read_b32 v22, a6
    v_accvgpr_read_b32 v23, a7
    v_accvgpr_read_b32 v24, a8
    v_accvgpr_read_b32 v25, a9
    v_accvgpr_read_b32 v26, a10
    v_accvgpr_read_b32 v27, a11
    v_accvgpr_read_b32 v28, a12
    v_accvgpr_read_b32 v29, a13
    v_accvgpr_read_b32 v30, a14
    v_accvgpr_read_b32 v31, a15
    v_accvgpr_read_b32 v32, a16
    v_accvgpr_read_b32 v33, a17
    v_accvgpr_read_b32 v34, a18
    v_accvgpr_read_b32 v35, a19
    v_accvgpr_read_b32 v36, a20
    v_accvgpr_read_b32 v37, a21
    v_accvgpr_read_b32 v38, a22
    v_accvgpr_read_b32 v39, a23
    v_accvgpr_read_b32 v40, a24
    v_accvgpr_read_b32 v41, a25
    v_accvgpr_read_b32 v42, a26
    v_accvgpr_read_b32 v43, a27
    v_accvgpr_read_b32 v44, a28
    v_accvgpr_read_b32 v45, a29
    v_accvgpr_read_b32 v46, a30
    v_accvgpr_read_b32 v47, a31
    v_accvgpr_read_b32 v48, a32
    v_accvgpr_read_b32 v49, a33
    v_accvgpr_read_b32 v50, a34
    v_accvgpr_read_b32 v51, a35
    v_accvgpr_read_b32 v52, a36
    v_accvgpr_read_b32 v53, a37
    v_accvgpr_read_b32 v54, a38
    v_accvgpr_read_b32 v55, a39
    v_accvgpr_read_b32 v56, a40
    v_accvgpr_read_b32 v57, a41
    v_accvgpr_read_b32 v58, a42
    v_accvgpr_read_b32 v59, a43
    v_accvgpr_read_b32 v60, a44
    v_accvgpr_read_b32 v61, a45
    v_accvgpr_read_b32 v62, a46
    v_accvgpr_read_b32 v63, a47
    v_accvgpr_read_b32 v64, a48
    v_accvgpr_read_b32 v65, a49
    v_accvgpr_read_b32 v66, a50
    v_accvgpr_read_b32 v67, a51
    v_accvgpr_read_b32 v68, a52
    v_accvgpr_read_b32 v69, a53
    v_accvgpr_read_b32 v70, a54
    v_accvgpr_read_b32 v71, a55
    v_accvgpr_read_b32 v72, a56
    v_accvgpr_read_b32 v73, a57
    v_accvgpr_read_b32 v74, a58
    v_accvgpr_read_b32 v75, a59
    v_accvgpr_read_b32 v76, a60
    v_accvgpr_read_b32 v77, a61
    v_accvgpr_read_b32 v78, a62
    v_accvgpr_read_b32 v79, a63
    v_accvgpr_read_b32 v80, a64
    v_accvgpr_read_b32 v81, a65
    v_accvgpr_read_b32 v82, a66
    v_accvgpr_read_b32 v83, a67
    v_accvgpr_read_b32 v84, a68
    v_accvgpr_read_b32 v85, a69
    v_accvgpr_read_b32 v86, a70
    v_accvgpr_read_b32 v87, a71
    v_accvgpr_read_b32 v88, a72
    v_accvgpr_read_b32 v89, a73
    v_accvgpr_read_b32 v90, a74
    v_accvgpr_read_b32 v91, a75
    v_accvgpr_read_b32 v92, a76
    v_accvgpr_read_b32 v93, a77
    v_accvgpr_read_b32 v94, a78
    v_accvgpr_read_b32 v95, a79
    v_min_f32 v150, 0, v16
    v_min_f32 v151, 0, v17
    v_mul_f32 v150, 0x3fb8aa3b, v150
    v_mul_f32 v151, 0x3fb8aa3b, v151
    v_exp_f32 v150, v150
    v_exp_f32 v151, v151
    v_max_f32 v149, 0, v16
    v_max_f32 v148, 0, v17
    v_add_f32 v149, v149, v150
    v_add_f32 v148, v148, v151
    v_add_f32 v149, 0x358637bd, v149
    v_add_f32 v148, 0x358637bd, v148
    v_cvt_pk_bf16_f32 v96, v149, v148
    v_min_f32 v150, 0, v18
    v_min_f32 v151, 0, v19
    v_mul_f32 v150, 0x3fb8aa3b, v150
    v_mul_f32 v151, 0x3fb8aa3b, v151
    v_exp_f32 v150, v150
    v_exp_f32 v151, v151
    v_max_f32 v149, 0, v18
    v_max_f32 v148, 0, v19
    v_add_f32 v149, v149, v150
    v_add_f32 v148, v148, v151
    v_add_f32 v149, 0x358637bd, v149
    v_add_f32 v148, 0x358637bd, v148
    v_cvt_pk_bf16_f32 v97, v149, v148
    v_min_f32 v150, 0, v20
    v_min_f32 v151, 0, v21
    v_mul_f32 v150, 0x3fb8aa3b, v150
    v_mul_f32 v151, 0x3fb8aa3b, v151
    v_exp_f32 v150, v150
    v_exp_f32 v151, v151
    v_max_f32 v149, 0, v20
    v_max_f32 v148, 0, v21
    v_add_f32 v149, v149, v150
    v_add_f32 v148, v148, v151
    v_add_f32 v149, 0x358637bd, v149
    v_add_f32 v148, 0x358637bd, v148
    v_cvt_pk_bf16_f32 v98, v149, v148
    v_min_f32 v150, 0, v22
    v_min_f32 v151, 0, v23
    v_mul_f32 v150, 0x3fb8aa3b, v150
    v_mul_f32 v151, 0x3fb8aa3b, v151
    v_exp_f32 v150, v150
    v_exp_f32 v151, v151
    v_max_f32 v149, 0, v22
    v_max_f32 v148, 0, v23
    v_add_f32 v149, v149, v150
    v_add_f32 v148, v148, v151
    v_add_f32 v149, 0x358637bd, v149
    v_add_f32 v148, 0x358637bd, v148
    v_cvt_pk_bf16_f32 v99, v149, v148
    v_min_f32 v150, 0, v24
    v_min_f32 v151, 0, v25
    v_mul_f32 v150, 0x3fb8aa3b, v150
    v_mul_f32 v151, 0x3fb8aa3b, v151
    v_exp_f32 v150, v150
    v_exp_f32 v151, v151
    v_max_f32 v149, 0, v24
    v_max_f32 v148, 0, v25
    v_add_f32 v149, v149, v150
    v_add_f32 v148, v148, v151
    v_add_f32 v149, 0x358637bd, v149
    v_add_f32 v148, 0x358637bd, v148
    v_cvt_pk_bf16_f32 v100, v149, v148
    v_min_f32 v150, 0, v26
    v_min_f32 v151, 0, v27
    v_mul_f32 v150, 0x3fb8aa3b, v150
    v_mul_f32 v151, 0x3fb8aa3b, v151
    v_exp_f32 v150, v150
    v_exp_f32 v151, v151
    v_max_f32 v149, 0, v26
    v_max_f32 v148, 0, v27
    v_add_f32 v149, v149, v150
    v_add_f32 v148, v148, v151
    v_add_f32 v149, 0x358637bd, v149
    v_add_f32 v148, 0x358637bd, v148
    v_cvt_pk_bf16_f32 v101, v149, v148
    v_min_f32 v150, 0, v28
    v_min_f32 v151, 0, v29
    v_mul_f32 v150, 0x3fb8aa3b, v150
    v_mul_f32 v151, 0x3fb8aa3b, v151
    v_exp_f32 v150, v150
    v_exp_f32 v151, v151
    v_max_f32 v149, 0, v28
    v_max_f32 v148, 0, v29
    v_add_f32 v149, v149, v150
    v_add_f32 v148, v148, v151
    v_add_f32 v149, 0x358637bd, v149
    v_add_f32 v148, 0x358637bd, v148
    v_cvt_pk_bf16_f32 v102, v149, v148
    v_min_f32 v150, 0, v30
    v_min_f32 v151, 0, v31
    v_mul_f32 v150, 0x3fb8aa3b, v150
    v_mul_f32 v151, 0x3fb8aa3b, v151
    v_exp_f32 v150, v150
    v_exp_f32 v151, v151
    v_max_f32 v149, 0, v30
    v_max_f32 v148, 0, v31
    v_add_f32 v149, v149, v150
    v_add_f32 v148, v148, v151
    v_add_f32 v149, 0x358637bd, v149
    v_add_f32 v148, 0x358637bd, v148
    v_cvt_pk_bf16_f32 v103, v149, v148
    v_min_f32 v150, 0, v32
    v_min_f32 v151, 0, v33
    v_mul_f32 v150, 0x3fb8aa3b, v150
    v_mul_f32 v151, 0x3fb8aa3b, v151
    v_exp_f32 v150, v150
    v_exp_f32 v151, v151
    v_max_f32 v149, 0, v32
    v_max_f32 v148, 0, v33
    v_add_f32 v149, v149, v150
    v_add_f32 v148, v148, v151
    v_add_f32 v149, 0x358637bd, v149
    v_add_f32 v148, 0x358637bd, v148
    v_cvt_pk_bf16_f32 v104, v149, v148
    v_min_f32 v150, 0, v34
    v_min_f32 v151, 0, v35
    v_mul_f32 v150, 0x3fb8aa3b, v150
    v_mul_f32 v151, 0x3fb8aa3b, v151
    v_exp_f32 v150, v150
    v_exp_f32 v151, v151
    v_max_f32 v149, 0, v34
    v_max_f32 v148, 0, v35
    v_add_f32 v149, v149, v150
    v_add_f32 v148, v148, v151
    v_add_f32 v149, 0x358637bd, v149
    v_add_f32 v148, 0x358637bd, v148
    v_cvt_pk_bf16_f32 v105, v149, v148
    v_min_f32 v150, 0, v36
    v_min_f32 v151, 0, v37
    v_mul_f32 v150, 0x3fb8aa3b, v150
    v_mul_f32 v151, 0x3fb8aa3b, v151
    v_exp_f32 v150, v150
    v_exp_f32 v151, v151
    v_max_f32 v149, 0, v36
    v_max_f32 v148, 0, v37
    v_add_f32 v149, v149, v150
    v_add_f32 v148, v148, v151
    v_add_f32 v149, 0x358637bd, v149
    v_add_f32 v148, 0x358637bd, v148
    v_cvt_pk_bf16_f32 v106, v149, v148
    v_min_f32 v150, 0, v38
    v_min_f32 v151, 0, v39
    v_mul_f32 v150, 0x3fb8aa3b, v150
    v_mul_f32 v151, 0x3fb8aa3b, v151
    v_exp_f32 v150, v150
    v_exp_f32 v151, v151
    v_max_f32 v149, 0, v38
    v_max_f32 v148, 0, v39
    v_add_f32 v149, v149, v150
    v_add_f32 v148, v148, v151
    v_add_f32 v149, 0x358637bd, v149
    v_add_f32 v148, 0x358637bd, v148
    v_cvt_pk_bf16_f32 v107, v149, v148
    v_min_f32 v150, 0, v40
    v_min_f32 v151, 0, v41
    v_mul_f32 v150, 0x3fb8aa3b, v150
    v_mul_f32 v151, 0x3fb8aa3b, v151
    v_exp_f32 v150, v150
    v_exp_f32 v151, v151
    v_max_f32 v149, 0, v40
    v_max_f32 v148, 0, v41
    v_add_f32 v149, v149, v150
    v_add_f32 v148, v148, v151
    v_add_f32 v149, 0x358637bd, v149
    v_add_f32 v148, 0x358637bd, v148
    v_cvt_pk_bf16_f32 v108, v149, v148
    v_min_f32 v150, 0, v42
    v_min_f32 v151, 0, v43
    v_mul_f32 v150, 0x3fb8aa3b, v150
    v_mul_f32 v151, 0x3fb8aa3b, v151
    v_exp_f32 v150, v150
    v_exp_f32 v151, v151
    v_max_f32 v149, 0, v42
    v_max_f32 v148, 0, v43
    v_add_f32 v149, v149, v150
    v_add_f32 v148, v148, v151
    v_add_f32 v149, 0x358637bd, v149
    v_add_f32 v148, 0x358637bd, v148
    v_cvt_pk_bf16_f32 v109, v149, v148
    v_min_f32 v150, 0, v44
    v_min_f32 v151, 0, v45
    v_mul_f32 v150, 0x3fb8aa3b, v150
    v_mul_f32 v151, 0x3fb8aa3b, v151
    v_exp_f32 v150, v150
    v_exp_f32 v151, v151
    v_max_f32 v149, 0, v44
    v_max_f32 v148, 0, v45
    v_add_f32 v149, v149, v150
    v_add_f32 v148, v148, v151
    v_add_f32 v149, 0x358637bd, v149
    v_add_f32 v148, 0x358637bd, v148
    v_cvt_pk_bf16_f32 v110, v149, v148
    v_min_f32 v150, 0, v46
    v_min_f32 v151, 0, v47
    v_mul_f32 v150, 0x3fb8aa3b, v150
    v_mul_f32 v151, 0x3fb8aa3b, v151
    v_exp_f32 v150, v150
    v_exp_f32 v151, v151
    v_max_f32 v149, 0, v46
    v_max_f32 v148, 0, v47
    v_add_f32 v149, v149, v150
    v_add_f32 v148, v148, v151
    v_add_f32 v149, 0x358637bd, v149
    v_add_f32 v148, 0x358637bd, v148
    v_cvt_pk_bf16_f32 v111, v149, v148
    v_min_f32 v150, 0, v48
    v_min_f32 v151, 0, v49
    v_mul_f32 v150, 0x3fb8aa3b, v150
    v_mul_f32 v151, 0x3fb8aa3b, v151
    v_exp_f32 v150, v150
    v_exp_f32 v151, v151
    v_max_f32 v149, 0, v48
    v_max_f32 v148, 0, v49
    v_add_f32 v149, v149, v150
    v_add_f32 v148, v148, v151
    v_add_f32 v149, 0x358637bd, v149
    v_add_f32 v148, 0x358637bd, v148
    v_cvt_pk_bf16_f32 v112, v149, v148
    v_min_f32 v150, 0, v50
    v_min_f32 v151, 0, v51
    v_mul_f32 v150, 0x3fb8aa3b, v150
    v_mul_f32 v151, 0x3fb8aa3b, v151
    v_exp_f32 v150, v150
    v_exp_f32 v151, v151
    v_max_f32 v149, 0, v50
    v_max_f32 v148, 0, v51
    v_add_f32 v149, v149, v150
    v_add_f32 v148, v148, v151
    v_add_f32 v149, 0x358637bd, v149
    v_add_f32 v148, 0x358637bd, v148
    v_cvt_pk_bf16_f32 v113, v149, v148
    v_min_f32 v150, 0, v52
    v_min_f32 v151, 0, v53
    v_mul_f32 v150, 0x3fb8aa3b, v150
    v_mul_f32 v151, 0x3fb8aa3b, v151
    v_exp_f32 v150, v150
    v_exp_f32 v151, v151
    v_max_f32 v149, 0, v52
    v_max_f32 v148, 0, v53
    v_add_f32 v149, v149, v150
    v_add_f32 v148, v148, v151
    v_add_f32 v149, 0x358637bd, v149
    v_add_f32 v148, 0x358637bd, v148
    v_cvt_pk_bf16_f32 v114, v149, v148
    v_min_f32 v150, 0, v54
    v_min_f32 v151, 0, v55
    v_mul_f32 v150, 0x3fb8aa3b, v150
    v_mul_f32 v151, 0x3fb8aa3b, v151
    v_exp_f32 v150, v150
    v_exp_f32 v151, v151
    v_max_f32 v149, 0, v54
    v_max_f32 v148, 0, v55
    v_add_f32 v149, v149, v150
    v_add_f32 v148, v148, v151
    v_add_f32 v149, 0x358637bd, v149
    v_add_f32 v148, 0x358637bd, v148
    v_cvt_pk_bf16_f32 v115, v149, v148
    v_min_f32 v150, 0, v56
    v_min_f32 v151, 0, v57
    v_mul_f32 v150, 0x3fb8aa3b, v150
    v_mul_f32 v151, 0x3fb8aa3b, v151
    v_exp_f32 v150, v150
    v_exp_f32 v151, v151
    v_max_f32 v149, 0, v56
    v_max_f32 v148, 0, v57
    v_add_f32 v149, v149, v150
    v_add_f32 v148, v148, v151
    v_add_f32 v149, 0x358637bd, v149
    v_add_f32 v148, 0x358637bd, v148
    v_cvt_pk_bf16_f32 v116, v149, v148
    v_min_f32 v150, 0, v58
    v_min_f32 v151, 0, v59
    v_mul_f32 v150, 0x3fb8aa3b, v150
    v_mul_f32 v151, 0x3fb8aa3b, v151
    v_exp_f32 v150, v150
    v_exp_f32 v151, v151
    v_max_f32 v149, 0, v58
    v_max_f32 v148, 0, v59
    v_add_f32 v149, v149, v150
    v_add_f32 v148, v148, v151
    v_add_f32 v149, 0x358637bd, v149
    v_add_f32 v148, 0x358637bd, v148
    v_cvt_pk_bf16_f32 v117, v149, v148
    v_min_f32 v150, 0, v60
    v_min_f32 v151, 0, v61
    v_mul_f32 v150, 0x3fb8aa3b, v150
    v_mul_f32 v151, 0x3fb8aa3b, v151
    v_exp_f32 v150, v150
    v_exp_f32 v151, v151
    v_max_f32 v149, 0, v60
    v_max_f32 v148, 0, v61
    v_add_f32 v149, v149, v150
    v_add_f32 v148, v148, v151
    v_add_f32 v149, 0x358637bd, v149
    v_add_f32 v148, 0x358637bd, v148
    v_cvt_pk_bf16_f32 v118, v149, v148
    v_min_f32 v150, 0, v62
    v_min_f32 v151, 0, v63
    v_mul_f32 v150, 0x3fb8aa3b, v150
    v_mul_f32 v151, 0x3fb8aa3b, v151
    v_exp_f32 v150, v150
    v_exp_f32 v151, v151
    v_max_f32 v149, 0, v62
    v_max_f32 v148, 0, v63
    v_add_f32 v149, v149, v150
    v_add_f32 v148, v148, v151
    v_add_f32 v149, 0x358637bd, v149
    v_add_f32 v148, 0x358637bd, v148
    v_cvt_pk_bf16_f32 v119, v149, v148
    v_cvt_pk_bf16_f32 v120, v48, v49
    v_cvt_pk_bf16_f32 v121, v50, v51
    v_cvt_pk_bf16_f32 v122, v52, v53
    v_cvt_pk_bf16_f32 v123, v54, v55
    v_cvt_pk_bf16_f32 v124, v56, v57
    v_cvt_pk_bf16_f32 v125, v58, v59
    v_cvt_pk_bf16_f32 v126, v60, v61
    v_cvt_pk_bf16_f32 v127, v62, v63
    v_cvt_pk_bf16_f32 v128, v64, v65
    v_cvt_pk_bf16_f32 v129, v66, v67
    v_cvt_pk_bf16_f32 v130, v68, v69
    v_cvt_pk_bf16_f32 v131, v70, v71
    v_cvt_pk_bf16_f32 v132, v72, v73
    v_cvt_pk_bf16_f32 v133, v74, v75
    v_cvt_pk_bf16_f32 v134, v76, v77
    v_cvt_pk_bf16_f32 v135, v78, v79
    v_cvt_pk_bf16_f32 v136, v80, v81
    v_cvt_pk_bf16_f32 v137, v82, v83
    v_cvt_pk_bf16_f32 v138, v84, v85
    v_cvt_pk_bf16_f32 v139, v86, v87
    v_cvt_pk_bf16_f32 v140, v88, v89
    v_cvt_pk_bf16_f32 v141, v90, v91
    v_cvt_pk_bf16_f32 v142, v92, v93
    v_cvt_pk_bf16_f32 v143, v94, v95
    v_mov_b32 v144, 0x3f803f80
    v_mov_b32 v145, 0x3f803f80
    v_mov_b32 v146, 0x3f803f80
    v_mov_b32 v147, 0x3f803f80
    s_barrier
    v_lshlrev_b32 v148, 4, v1
    s_mul_i32 s33, s28, 12288
    v_add_u32 v149, s33, v148
    ds_write_b128 v149, v[96:99] offset:0
    ds_write_b128 v149, v[100:103] offset:1024
    ds_write_b128 v149, v[104:107] offset:2048
    ds_write_b128 v149, v[108:111] offset:3072
    ds_write_b128 v149, v[112:115] offset:4096
    ds_write_b128 v149, v[116:119] offset:5120
    ds_write_b128 v149, v[120:123] offset:6144
    ds_write_b128 v149, v[124:127] offset:7168
    ds_write_b128 v149, v[128:131] offset:8192
    ds_write_b128 v149, v[132:135] offset:9216
    ds_write_b128 v149, v[136:139] offset:10240
    ds_write_b128 v149, v[140:143] offset:11264
    s_waitcnt lgkmcnt(0)
    s_barrier
    s_lshl_b32 s33, s28, 1
    s_add_u32 s33, s33, 0
    s_cmp_ge_u32 s33, 5
    s_cbranch_scc1 K1_RZ0
    s_lshr_b32 s35, s33, 1
    s_lshl_b32 s35, s35, 11
    s_add_u32 s36, s33, 1
    s_lshr_b32 s36, s36, 1
    s_lshl_b32 s36, s36, 11
    s_add_u32 s36, s36, 6144
    v_add_u32 v149, s35, v148
    v_add_u32 v150, s36, v148
    ds_read_b128 v[16:19], v150 offset:0
    ds_read_b128 v[20:23], v149 offset:0
    ds_read_b128 v[24:27], v150 offset:1024
    ds_read_b128 v[28:31], v149 offset:1024
    ds_read_b128 v[32:35], v150 offset:12288
    ds_read_b128 v[36:39], v149 offset:12288
    ds_read_b128 v[40:43], v150 offset:13312
    ds_read_b128 v[44:47], v149 offset:13312
    ds_read_b128 v[48:51], v150 offset:24576
    ds_read_b128 v[52:55], v149 offset:24576
    ds_read_b128 v[56:59], v150 offset:25600
    ds_read_b128 v[60:63], v149 offset:25600
    ds_read_b128 v[64:67], v150 offset:36864
    ds_read_b128 v[68:71], v149 offset:36864
    ds_read_b128 v[72:75], v150 offset:37888
    ds_read_b128 v[76:79], v149 offset:37888
    s_waitcnt lgkmcnt(14)
    v_mfma_f32_32x32x16_bf16 v[96:111], v[16:19], v[20:23], 0
    s_waitcnt lgkmcnt(12)
    v_mfma_f32_32x32x16_bf16 v[96:111], v[24:27], v[28:31], v[96:111]
    s_waitcnt lgkmcnt(10)
    v_mfma_f32_32x32x16_bf16 v[96:111], v[32:35], v[36:39], v[96:111]
    s_waitcnt lgkmcnt(8)
    v_mfma_f32_32x32x16_bf16 v[96:111], v[40:43], v[44:47], v[96:111]
    s_waitcnt lgkmcnt(6)
    v_mfma_f32_32x32x16_bf16 v[96:111], v[48:51], v[52:55], v[96:111]
    s_waitcnt lgkmcnt(4)
    v_mfma_f32_32x32x16_bf16 v[96:111], v[56:59], v[60:63], v[96:111]
    s_waitcnt lgkmcnt(2)
    v_mfma_f32_32x32x16_bf16 v[96:111], v[64:67], v[68:71], v[96:111]
    s_waitcnt lgkmcnt(0)
    v_mfma_f32_32x32x16_bf16 v[96:111], v[72:75], v[76:79], v[96:111]
    s_branch K1_RD0
K1_RZ0:
    s_sub_u32 s35, s33, 5
    s_lshl_b32 s35, s35, 11
    v_add_u32 v149, s35, v148
    ds_read_b128 v[20:23], v149 offset:0
    ds_read_b128 v[28:31], v149 offset:1024
    ds_read_b128 v[36:39], v149 offset:12288
    ds_read_b128 v[44:47], v149 offset:13312
    ds_read_b128 v[52:55], v149 offset:24576
    ds_read_b128 v[60:63], v149 offset:25600
    ds_read_b128 v[68:71], v149 offset:36864
    ds_read_b128 v[76:79], v149 offset:37888
    s_waitcnt lgkmcnt(7)
    v_mfma_f32_32x32x16_bf16 v[96:111], v[144:147], v[20:23], 0
    s_waitcnt lgkmcnt(6)
    v_mfma_f32_32x32x16_bf16 v[96:111], v[144:147], v[28:31], v[96:111]
    s_waitcnt lgkmcnt(5)
    v_mfma_f32_32x32x16_bf16 v[96:111], v[144:147], v[36:39], v[96:111]
    s_waitcnt lgkmcnt(4)
    v_mfma_f32_32x32x16_bf16 v[96:111], v[144:147], v[44:47], v[96:111]
    s_waitcnt lgkmcnt(3)
    v_mfma_f32_32x32x16_bf16 v[96:111], v[144:147], v[52:55], v[96:111]
    s_waitcnt lgkmcnt(2)
    v_mfma_f32_32x32x16_bf16 v[96:111], v[144:147], v[60:63], v[96:111]
    s_waitcnt lgkmcnt(1)
    v_mfma_f32_32x32x16_bf16 v[96:111], v[144:147], v[68:71], v[96:111]
    s_waitcnt lgkmcnt(0)
    v_mfma_f32_32x32x16_bf16 v[96:111], v[144:147], v[76:79], v[96:111]
K1_RD0:
    s_lshl_b32 s33, s28, 1
    s_add_u32 s33, s33, 1
    s_cmp_ge_u32 s33, 5
    s_cbranch_scc1 K1_RZ1
    s_lshr_b32 s35, s33, 1
    s_lshl_b32 s35, s35, 11
    s_add_u32 s36, s33, 1
    s_lshr_b32 s36, s36, 1
    s_lshl_b32 s36, s36, 11
    s_add_u32 s36, s36, 6144
    v_add_u32 v149, s35, v148
    v_add_u32 v150, s36, v148
    ds_read_b128 v[16:19], v150 offset:0
    ds_read_b128 v[20:23], v149 offset:0
    ds_read_b128 v[24:27], v150 offset:1024
    ds_read_b128 v[28:31], v149 offset:1024
    ds_read_b128 v[32:35], v150 offset:12288
    ds_read_b128 v[36:39], v149 offset:12288
    ds_read_b128 v[40:43], v150 offset:13312
    ds_read_b128 v[44:47], v149 offset:13312
    ds_read_b128 v[48:51], v150 offset:24576
    ds_read_b128 v[52:55], v149 offset:24576
    ds_read_b128 v[56:59], v150 offset:25600
    ds_read_b128 v[60:63], v149 offset:25600
    ds_read_b128 v[64:67], v150 offset:36864
    ds_read_b128 v[68:71], v149 offset:36864
    ds_read_b128 v[72:75], v150 offset:37888
    ds_read_b128 v[76:79], v149 offset:37888
    s_waitcnt lgkmcnt(14)
    v_mfma_f32_32x32x16_bf16 v[112:127], v[16:19], v[20:23], 0
    s_waitcnt lgkmcnt(12)
    v_mfma_f32_32x32x16_bf16 v[112:127], v[24:27], v[28:31], v[112:127]
    s_waitcnt lgkmcnt(10)
    v_mfma_f32_32x32x16_bf16 v[112:127], v[32:35], v[36:39], v[112:127]
    s_waitcnt lgkmcnt(8)
    v_mfma_f32_32x32x16_bf16 v[112:127], v[40:43], v[44:47], v[112:127]
    s_waitcnt lgkmcnt(6)
    v_mfma_f32_32x32x16_bf16 v[112:127], v[48:51], v[52:55], v[112:127]
    s_waitcnt lgkmcnt(4)
    v_mfma_f32_32x32x16_bf16 v[112:127], v[56:59], v[60:63], v[112:127]
    s_waitcnt lgkmcnt(2)
    v_mfma_f32_32x32x16_bf16 v[112:127], v[64:67], v[68:71], v[112:127]
    s_waitcnt lgkmcnt(0)
    v_mfma_f32_32x32x16_bf16 v[112:127], v[72:75], v[76:79], v[112:127]
    s_branch K1_RD1
K1_RZ1:
    s_sub_u32 s35, s33, 5
    s_lshl_b32 s35, s35, 11
    v_add_u32 v149, s35, v148
    ds_read_b128 v[20:23], v149 offset:0
    ds_read_b128 v[28:31], v149 offset:1024
    ds_read_b128 v[36:39], v149 offset:12288
    ds_read_b128 v[44:47], v149 offset:13312
    ds_read_b128 v[52:55], v149 offset:24576
    ds_read_b128 v[60:63], v149 offset:25600
    ds_read_b128 v[68:71], v149 offset:36864
    ds_read_b128 v[76:79], v149 offset:37888
    s_waitcnt lgkmcnt(7)
    v_mfma_f32_32x32x16_bf16 v[112:127], v[144:147], v[20:23], 0
    s_waitcnt lgkmcnt(6)
    v_mfma_f32_32x32x16_bf16 v[112:127], v[144:147], v[28:31], v[112:127]
    s_waitcnt lgkmcnt(5)
    v_mfma_f32_32x32x16_bf16 v[112:127], v[144:147], v[36:39], v[112:127]
    s_waitcnt lgkmcnt(4)
    v_mfma_f32_32x32x16_bf16 v[112:127], v[144:147], v[44:47], v[112:127]
    s_waitcnt lgkmcnt(3)
    v_mfma_f32_32x32x16_bf16 v[112:127], v[144:147], v[52:55], v[112:127]
    s_waitcnt lgkmcnt(2)
    v_mfma_f32_32x32x16_bf16 v[112:127], v[144:147], v[60:63], v[112:127]
    s_waitcnt lgkmcnt(1)
    v_mfma_f32_32x32x16_bf16 v[112:127], v[144:147], v[68:71], v[112:127]
    s_waitcnt lgkmcnt(0)
    v_mfma_f32_32x32x16_bf16 v[112:127], v[144:147], v[76:79], v[112:127]
K1_RD1:
    s_nop 15
    s_lshl_b32 s33, s30, 2
    s_add_u32 s38, s24, s33
    s_addc_u32 s39, s25, 0
    v_mov_b32 v150, 0
K1_POLL:
    global_load_dword v151, v150, s[38:39] sc0 sc1
    s_waitcnt vmcnt(0)
    v_readfirstlane_b32 s33, v151
    s_cmp_lt_u32 s33, 4
    s_cbranch_scc1 K1_POLL
    v_and_b32 v150, 31, v1
    v_lshrrev_b32 v151, 5, v1
    v_lshlrev_b32 v151, 2, v151
    s_mul_i32 s34, s30, 6400
    s_movk_i32 s37, 3277
    v_mov_b32 v158, 0x7ffffff0
    s_lshl_b32 s33, s28, 1
    s_add_u32 s33, s33, 0
    s_cmp_ge_u32 s33, 5
    s_cbranch_scc1 K1_ZT0
    s_lshr_b32 s35, s33, 1
    s_lshl_b32 s35, s35, 5
    s_add_u32 s36, s33, 1
    s_lshr_b32 s36, s36, 1
    s_lshl_b32 s36, s36, 5
    s_sub_u32 s36, s36, 16
    v_add_u32 v152, s35, v150
    v_mul_u32_u24 v153, s37, v152
    v_lshrrev_b32 v153, 16, v153
    v_mul_u32_u24 v153, 20, v153
    v_add_u32 v154, s36, v151
    v_sub_u32 v155, v154, v153
    v_mul_i32_i24 v156, 20, v154
    v_add_u32 v156, v156, v152
    v_sub_u32 v156, v156, v153
    v_lshlrev_b32 v156, 2, v156
    v_add_u32 v157, 0, v155
    v_cmp_gt_u32 vcc, 20, v157
    v_add_u32 v157, 0, v156
    s_nop 0
    v_cndmask_b32 v157, v158, v157, vcc
    buffer_atomic_add_f32 v96, v157, s[20:23], s34 offen
    v_add_u32 v157, 1, v155
    v_cmp_gt_u32 vcc, 20, v157
    v_add_u32 v157, 80, v156
    s_nop 0
    v_cndmask_b32 v157, v158, v157, vcc
    buffer_atomic_add_f32 v97, v157, s[20:23], s34 offen
    v_add_u32 v157, 2, v155
    v_cmp_gt_u32 vcc, 20, v157
    v_add_u32 v157, 160, v156
    s_nop 0
    v_cndmask_b32 v157, v158, v157, vcc
    buffer_atomic_add_f32 v98, v157, s[20:23], s34 offen
    v_add_u32 v157, 3, v155
    v_cmp_gt_u32 vcc, 20, v157
    v_add_u32 v157, 240, v156
    s_nop 0
    v_cndmask_b32 v157, v158, v157, vcc
    buffer_atomic_add_f32 v99, v157, s[20:23], s34 offen
    v_add_u32 v157, 8, v155
    v_cmp_gt_u32 vcc, 20, v157
    v_add_u32 v157, 640, v156
    s_nop 0
    v_cndmask_b32 v157, v158, v157, vcc
    buffer_atomic_add_f32 v100, v157, s[20:23], s34 offen
    v_add_u32 v157, 9, v155
    v_cmp_gt_u32 vcc, 20, v157
    v_add_u32 v157, 720, v156
    s_nop 0
    v_cndmask_b32 v157, v158, v157, vcc
    buffer_atomic_add_f32 v101, v157, s[20:23], s34 offen
    v_add_u32 v157, 10, v155
    v_cmp_gt_u32 vcc, 20, v157
    v_add_u32 v157, 800, v156
    s_nop 0
    v_cndmask_b32 v157, v158, v157, vcc
    buffer_atomic_add_f32 v102, v157, s[20:23], s34 offen
    v_add_u32 v157, 11, v155
    v_cmp_gt_u32 vcc, 20, v157
    v_add_u32 v157, 880, v156
    s_nop 0
    v_cndmask_b32 v157, v158, v157, vcc
    buffer_atomic_add_f32 v103, v157, s[20:23], s34 offen
    v_add_u32 v157, 16, v155
    v_cmp_gt_u32 vcc, 20, v157
    v_add_u32 v157, 1280, v156
    s_nop 0
    v_cndmask_b32 v157, v158, v157, vcc
    buffer_atomic_add_f32 v104, v157, s[20:23], s34 offen
    v_add_u32 v157, 17, v155
    v_cmp_gt_u32 vcc, 20, v157
    v_add_u32 v157, 1360, v156
    s_nop 0
    v_cndmask_b32 v157, v158, v157, vcc
    buffer_atomic_add_f32 v105, v157, s[20:23], s34 offen
    v_add_u32 v157, 18, v155
    v_cmp_gt_u32 vcc, 20, v157
    v_add_u32 v157, 1440, v156
    s_nop 0
    v_cndmask_b32 v157, v158, v157, vcc
    buffer_atomic_add_f32 v106, v157, s[20:23], s34 offen
    v_add_u32 v157, 19, v155
    v_cmp_gt_u32 vcc, 20, v157
    v_add_u32 v157, 1520, v156
    s_nop 0
    v_cndmask_b32 v157, v158, v157, vcc
    buffer_atomic_add_f32 v107, v157, s[20:23], s34 offen
    v_add_u32 v157, 24, v155
    v_cmp_gt_u32 vcc, 20, v157
    v_add_u32 v157, 1920, v156
    s_nop 0
    v_cndmask_b32 v157, v158, v157, vcc
    buffer_atomic_add_f32 v108, v157, s[20:23], s34 offen
    v_add_u32 v157, 25, v155
    v_cmp_gt_u32 vcc, 20, v157
    v_add_u32 v157, 2000, v156
    s_nop 0
    v_cndmask_b32 v157, v158, v157, vcc
    buffer_atomic_add_f32 v109, v157, s[20:23], s34 offen
    v_add_u32 v157, 26, v155
    v_cmp_gt_u32 vcc, 20, v157
    v_add_u32 v157, 2080, v156
    s_nop 0
    v_cndmask_b32 v157, v158, v157, vcc
    buffer_atomic_add_f32 v110, v157, s[20:23], s34 offen
    v_add_u32 v157, 27, v155
    v_cmp_gt_u32 vcc, 20, v157
    v_add_u32 v157, 2160, v156
    s_nop 0
    v_cndmask_b32 v157, v158, v157, vcc
    buffer_atomic_add_f32 v111, v157, s[20:23], s34 offen
    s_branch K1_ZD0
K1_ZT0:
    s_sub_u32 s35, s33, 5
    s_lshl_b32 s35, s35, 5
    v_add_u32 v152, s35, v150
    v_lshlrev_b32 v157, 2, v152
    v_cmp_gt_u32 vcc, 80, v152
    v_cmp_gt_u32 s[40:41], 32, v1
    s_and_b64 vcc, vcc, s[40:41]
    s_nop 1
    v_cndmask_b32 v157, v158, v157, vcc
    s_mul_i32 s35, s30, 320
    s_add_u32 s35, s35, 51200
    buffer_atomic_add_f32 v96, v157, s[20:23], s35 offen
K1_ZD0:
    s_lshl_b32 s33, s28, 1
    s_add_u32 s33, s33, 1
    s_cmp_ge_u32 s33, 5
    s_cbranch_scc1 K1_ZT1
    s_lshr_b32 s35, s33, 1
    s_lshl_b32 s35, s35, 5
    s_add_u32 s36, s33, 1
    s_lshr_b32 s36, s36, 1
    s_lshl_b32 s36, s36, 5
    s_sub_u32 s36, s36, 16
    v_add_u32 v152, s35, v150
    v_mul_u32_u24 v153, s37, v152
    v_lshrrev_b32 v153, 16, v153
    v_mul_u32_u24 v153, 20, v153
    v_add_u32 v154, s36, v151
    v_sub_u32 v155, v154, v153
    v_mul_i32_i24 v156, 20, v154
    v_add_u32 v156, v156, v152
    v_sub_u32 v156, v156, v153
    v_lshlrev_b32 v156, 2, v156
    v_add_u32 v157, 0, v155
    v_cmp_gt_u32 vcc, 20, v157
    v_add_u32 v157, 0, v156
    s_nop 0
    v_cndmask_b32 v157, v158, v157, vcc
    buffer_atomic_add_f32 v112, v157, s[20:23], s34 offen
    v_add_u32 v157, 1, v155
    v_cmp_gt_u32 vcc, 20, v157
    v_add_u32 v157, 80, v156
    s_nop 0
    v_cndmask_b32 v157, v158, v157, vcc
    buffer_atomic_add_f32 v113, v157, s[20:23], s34 offen
    v_add_u32 v157, 2, v155
    v_cmp_gt_u32 vcc, 20, v157
    v_add_u32 v157, 160, v156
    s_nop 0
    v_cndmask_b32 v157, v158, v157, vcc
    buffer_atomic_add_f32 v114, v157, s[20:23], s34 offen
    v_add_u32 v157, 3, v155
    v_cmp_gt_u32 vcc, 20, v157
    v_add_u32 v157, 240, v156
    s_nop 0
    v_cndmask_b32 v157, v158, v157, vcc
    buffer_atomic_add_f32 v115, v157, s[20:23], s34 offen
    v_add_u32 v157, 8, v155
    v_cmp_gt_u32 vcc, 20, v157
    v_add_u32 v157, 640, v156
    s_nop 0
    v_cndmask_b32 v157, v158, v157, vcc
    buffer_atomic_add_f32 v116, v157, s[20:23], s34 offen
    v_add_u32 v157, 9, v155
    v_cmp_gt_u32 vcc, 20, v157
    v_add_u32 v157, 720, v156
    s_nop 0
    v_cndmask_b32 v157, v158, v157, vcc
    buffer_atomic_add_f32 v117, v157, s[20:23], s34 offen
    v_add_u32 v157, 10, v155
    v_cmp_gt_u32 vcc, 20, v157
    v_add_u32 v157, 800, v156
    s_nop 0
    v_cndmask_b32 v157, v158, v157, vcc
    buffer_atomic_add_f32 v118, v157, s[20:23], s34 offen
    v_add_u32 v157, 11, v155
    v_cmp_gt_u32 vcc, 20, v157
    v_add_u32 v157, 880, v156
    s_nop 0
    v_cndmask_b32 v157, v158, v157, vcc
    buffer_atomic_add_f32 v119, v157, s[20:23], s34 offen
    v_add_u32 v157, 16, v155
    v_cmp_gt_u32 vcc, 20, v157
    v_add_u32 v157, 1280, v156
    s_nop 0
    v_cndmask_b32 v157, v158, v157, vcc
    buffer_atomic_add_f32 v120, v157, s[20:23], s34 offen
    v_add_u32 v157, 17, v155
    v_cmp_gt_u32 vcc, 20, v157
    v_add_u32 v157, 1360, v156
    s_nop 0
    v_cndmask_b32 v157, v158, v157, vcc
    buffer_atomic_add_f32 v121, v157, s[20:23], s34 offen
    v_add_u32 v157, 18, v155
    v_cmp_gt_u32 vcc, 20, v157
    v_add_u32 v157, 1440, v156
    s_nop 0
    v_cndmask_b32 v157, v158, v157, vcc
    buffer_atomic_add_f32 v122, v157, s[20:23], s34 offen
    v_add_u32 v157, 19, v155
    v_cmp_gt_u32 vcc, 20, v157
    v_add_u32 v157, 1520, v156
    s_nop 0
    v_cndmask_b32 v157, v158, v157, vcc
    buffer_atomic_add_f32 v123, v157, s[20:23], s34 offen
    v_add_u32 v157, 24, v155
    v_cmp_gt_u32 vcc, 20, v157
    v_add_u32 v157, 1920, v156
    s_nop 0
    v_cndmask_b32 v157, v158, v157, vcc
    buffer_atomic_add_f32 v124, v157, s[20:23], s34 offen
    v_add_u32 v157, 25, v155
    v_cmp_gt_u32 vcc, 20, v157
    v_add_u32 v157, 2000, v156
    s_nop 0
    v_cndmask_b32 v157, v158, v157, vcc
    buffer_atomic_add_f32 v125, v157, s[20:23], s34 offen
    v_add_u32 v157, 26, v155
    v_cmp_gt_u32 vcc, 20, v157
    v_add_u32 v157, 2080, v156
    s_nop 0
    v_cndmask_b32 v157, v158, v157, vcc
    buffer_atomic_add_f32 v126, v157, s[20:23], s34 offen
    v_add_u32 v157, 27, v155
    v_cmp_gt_u32 vcc, 20, v157
    v_add_u32 v157, 2160, v156
    s_nop 0
    v_cndmask_b32 v157, v158, v157, vcc
    buffer_atomic_add_f32 v127, v157, s[20:23], s34 offen
    s_branch K1_ZD1
K1_ZT1:
    s_sub_u32 s35, s33, 5
    s_lshl_b32 s35, s35, 5
    v_add_u32 v152, s35, v150
    v_lshlrev_b32 v157, 2, v152
    v_cmp_gt_u32 vcc, 80, v152
    v_cmp_gt_u32 s[40:41], 32, v1
    s_and_b64 vcc, vcc, s[40:41]
    s_nop 1
    v_cndmask_b32 v157, v158, v157, vcc
    s_mul_i32 s35, s30, 320
    s_add_u32 s35, s35, 51200
    buffer_atomic_add_f32 v112, v157, s[20:23], s35 offen
K1_ZD1:
    s_endpgm
K1_QLOOP:
    s_barrier
    ds_read_b128 v[96:99], v2
    ds_read_b64_tr_b16 v[16:17], v8 offset:0
    ds_read_b64_tr_b16 v[18:19], v8 offset:1280
    ds_read_b64_tr_b16 v[20:21], v8 offset:64
    ds_read_b64_tr_b16 v[22:23], v8 offset:1344
    ds_read_b64_tr_b16 v[24:25], v8 offset:128
    ds_read_b64_tr_b16 v[26:27], v8 offset:1408
    ds_read_b64_tr_b16 v[28:29], v8 offset:192
    ds_read_b64_tr_b16 v[30:31], v8 offset:1472
    ds_read_b64_tr_b16 v[32:33], v8 offset:256
    ds_read_b64_tr_b16 v[34:35], v8 offset:1536
    ds_read_b128 v[100:103], v3
    ds_read_b64_tr_b16 v[36:37], v8 offset:2560
    ds_read_b64_tr_b16 v[38:39], v8 offset:3840
    ds_read_b64_tr_b16 v[40:41], v8 offset:2624
    ds_read_b64_tr_b16 v[42:43], v8 offset:3904
    ds_read_b64_tr_b16 v[44:45], v8 offset:2688
    ds_read_b64_tr_b16 v[46:47], v8 offset:3968
    ds_read_b64_tr_b16 v[48:49], v8 offset:2752
    ds_read_b64_tr_b16 v[50:51], v8 offset:4032
    ds_read_b64_tr_b16 v[52:53], v8 offset:2816
    ds_read_b64_tr_b16 v[54:55], v8 offset:4096
    s_mov_b32 s41, 36864
K1_LOOP_Q:
    v_add_u32 v112, s40, v8
    v_add_u32 v115, s40, v4
    v_add_u32 v116, s40, v5
    v_add_u32 v117, s41, v8
    v_add_u32 v118, s41, v2
    v_add_u32 v119, s41, v3
    s_barrier
    s_waitcnt lgkmcnt(11)
    ds_read_b128 v[104:107], v115
    ds_read_b64_tr_b16 v[56:57], v112 offset:5120
    ds_read_b64_tr_b16 v[58:59], v112 offset:6400
    ds_read_b64_tr_b16 v[60:61], v112 offset:5184
    ds_read_b64_tr_b16 v[62:63], v112 offset:6464
    ds_read_b64_tr_b16 v[64:65], v112 offset:5248
    ds_read_b64_tr_b16 v[66:67], v112 offset:6528
    ds_read_b64_tr_b16 v[68:69], v112 offset:5312
    ds_read_b64_tr_b16 v[70:71], v112 offset:6592
    ds_read_b64_tr_b16 v[72:73], v112 offset:5376
    ds_read_b64_tr_b16 v[74:75], v112 offset:6656
    v_mfma_f32_32x32x16_bf16 a[0:15], v[16:19], v[96:99], a[0:15]
    v_mfma_f32_32x32x16_bf16 a[16:31], v[20:23], v[96:99], a[16:31]
    v_mfma_f32_32x32x16_bf16 a[32:47], v[24:27], v[96:99], a[32:47]
    v_mfma_f32_32x32x16_bf16 a[48:63], v[28:31], v[96:99], a[48:63]
    v_mfma_f32_32x32x16_bf16 a[64:79], v[32:35], v[96:99], a[64:79]
    s_waitcnt lgkmcnt(11)
    ds_read_b128 v[108:111], v116
    ds_read_b64_tr_b16 v[76:77], v112 offset:7680
    ds_read_b64_tr_b16 v[78:79], v112 offset:8960
    ds_read_b64_tr_b16 v[80:81], v112 offset:7744
    ds_read_b64_tr_b16 v[82:83], v112 offset:9024
    ds_read_b64_tr_b16 v[84:85], v112 offset:7808
    ds_read_b64_tr_b16 v[86:87], v112 offset:9088
    ds_read_b64_tr_b16 v[88:89], v112 offset:7872
    ds_read_b64_tr_b16 v[90:91], v112 offset:9152
    ds_read_b64_tr_b16 v[92:93], v112 offset:7936
    ds_read_b64_tr_b16 v[94:95], v112 offset:9216
    v_mfma_f32_32x32x16_bf16 a[0:15], v[36:39], v[100:103], a[0:15]
    v_mfma_f32_32x32x16_bf16 a[16:31], v[40:43], v[100:103], a[16:31]
    v_mfma_f32_32x32x16_bf16 a[32:47], v[44:47], v[100:103], a[32:47]
    v_mfma_f32_32x32x16_bf16 a[48:63], v[48:51], v[100:103], a[48:63]
    v_mfma_f32_32x32x16_bf16 a[64:79], v[52:55], v[100:103], a[64:79]
    s_waitcnt lgkmcnt(11)
    ds_read_b128 v[96:99], v118
    ds_read_b64_tr_b16 v[16:17], v117 offset:0
    ds_read_b64_tr_b16 v[18:19], v117 offset:1280
    ds_read_b64_tr_b16 v[20:21], v117 offset:64
    ds_read_b64_tr_b16 v[22:23], v117 offset:1344
    ds_read_b64_tr_b16 v[24:25], v117 offset:128
    ds_read_b64_tr_b16 v[26:27], v117 offset:1408
    ds_read_b64_tr_b16 v[28:29], v117 offset:192
    ds_read_b64_tr_b16 v[30:31], v117 offset:1472
    ds_read_b64_tr_b16 v[32:33], v117 offset:256
    ds_read_b64_tr_b16 v[34:35], v117 offset:1536
    v_mfma_f32_32x32x16_bf16 a[0:15], v[56:59], v[104:107], a[0:15]
    v_mfma_f32_32x32x16_bf16 a[16:31], v[60:63], v[104:107], a[16:31]
    v_mfma_f32_32x32x16_bf16 a[32:47], v[64:67], v[104:107], a[32:47]
    v_mfma_f32_32x32x16_bf16 a[48:63], v[68:71], v[104:107], a[48:63]
    v_mfma_f32_32x32x16_bf16 a[64:79], v[72:75], v[104:107], a[64:79]
    s_waitcnt lgkmcnt(11)
    ds_read_b128 v[100:103], v119
    ds_read_b64_tr_b16 v[36:37], v117 offset:2560
    ds_read_b64_tr_b16 v[38:39], v117 offset:3840
    ds_read_b64_tr_b16 v[40:41], v117 offset:2624
    ds_read_b64_tr_b16 v[42:43], v117 offset:3904
    ds_read_b64_tr_b16 v[44:45], v117 offset:2688
    ds_read_b64_tr_b16 v[46:47], v117 offset:3968
    ds_read_b64_tr_b16 v[48:49], v117 offset:2752
    ds_read_b64_tr_b16 v[50:51], v117 offset:4032
    ds_read_b64_tr_b16 v[52:53], v117 offset:2816
    ds_read_b64_tr_b16 v[54:55], v117 offset:4096
    v_mfma_f32_32x32x16_bf16 a[0:15], v[76:79], v[108:111], a[0:15]
    v_mfma_f32_32x32x16_bf16 a[16:31], v[80:83], v[108:111], a[16:31]
    v_mfma_f32_32x32x16_bf16 a[32:47], v[84:87], v[108:111], a[32:47]
    v_mfma_f32_32x32x16_bf16 a[48:63], v[88:91], v[108:111], a[48:63]
    v_mfma_f32_32x32x16_bf16 a[64:79], v[92:95], v[108:111], a[64:79]
    s_mov_b32 s40, s41
    s_add_u32 s41, s41, 36864
    s_cmp_eq_u32 s41, 147456
    s_cselect_b32 s41, 0, s41
    s_add_u32 s42, s42, 1
    s_cmp_lt_u32 s42, 10
    s_cbranch_scc1 K1_LOOP_Q
    s_waitcnt lgkmcnt(0)
    s_nop 15
    v_accvgpr_read_b32 v16, a0
    v_accvgpr_read_b32 v17, a1
    v_accvgpr_read_b32 v18, a2
    v_accvgpr_read_b32 v19, a3
    v_accvgpr_read_b32 v20, a4
    v_accvgpr_read_b32 v21, a5
    v_accvgpr_read_b32 v22, a6
    v_accvgpr_read_b32 v23, a7
    v_accvgpr_read_b32 v24, a8
    v_accvgpr_read_b32 v25, a9
    v_accvgpr_read_b32 v26, a10
    v_accvgpr_read_b32 v27, a11
    v_accvgpr_read_b32 v28, a12
    v_accvgpr_read_b32 v29, a13
    v_accvgpr_read_b32 v30, a14
    v_accvgpr_read_b32 v31, a15
    v_accvgpr_read_b32 v32, a16
    v_accvgpr_read_b32 v33, a17
    v_accvgpr_read_b32 v34, a18
    v_accvgpr_read_b32 v35, a19
    v_accvgpr_read_b32 v36, a20
    v_accvgpr_read_b32 v37, a21
    v_accvgpr_read_b32 v38, a22
    v_accvgpr_read_b32 v39, a23
    v_accvgpr_read_b32 v40, a24
    v_accvgpr_read_b32 v41, a25
    v_accvgpr_read_b32 v42, a26
    v_accvgpr_read_b32 v43, a27
    v_accvgpr_read_b32 v44, a28
    v_accvgpr_read_b32 v45, a29
    v_accvgpr_read_b32 v46, a30
    v_accvgpr_read_b32 v47, a31
    v_accvgpr_read_b32 v48, a32
    v_accvgpr_read_b32 v49, a33
    v_accvgpr_read_b32 v50, a34
    v_accvgpr_read_b32 v51, a35
    v_accvgpr_read_b32 v52, a36
    v_accvgpr_read_b32 v53, a37
    v_accvgpr_read_b32 v54, a38
    v_accvgpr_read_b32 v55, a39
    v_accvgpr_read_b32 v56, a40
    v_accvgpr_read_b32 v57, a41
    v_accvgpr_read_b32 v58, a42
    v_accvgpr_read_b32 v59, a43
    v_accvgpr_read_b32 v60, a44
    v_accvgpr_read_b32 v61, a45
    v_accvgpr_read_b32 v62, a46
    v_accvgpr_read_b32 v63, a47
    v_accvgpr_read_b32 v64, a48
    v_accvgpr_read_b32 v65, a49
    v_accvgpr_read_b32 v66, a50
    v_accvgpr_read_b32 v67, a51
    v_accvgpr_read_b32 v68, a52
    v_accvgpr_read_b32 v69, a53
    v_accvgpr_read_b32 v70, a54
    v_accvgpr_read_b32 v71, a55
    v_accvgpr_read_b32 v72, a56
    v_accvgpr_read_b32 v73, a57
    v_accvgpr_read_b32 v74, a58
    v_accvgpr_read_b32 v75, a59
    v_accvgpr_read_b32 v76, a60
    v_accvgpr_read_b32 v77, a61
    v_accvgpr_read_b32 v78, a62
    v_accvgpr_read_b32 v79, a63
    v_accvgpr_read_b32 v80, a64
    v_accvgpr_read_b32 v81, a65
    v_accvgpr_read_b32 v82, a66
    v_accvgpr_read_b32 v83, a67
    v_accvgpr_read_b32 v84, a68
    v_accvgpr_read_b32 v85, a69
    v_accvgpr_read_b32 v86, a70
    v_accvgpr_read_b32 v87, a71
    v_accvgpr_read_b32 v88, a72
    v_accvgpr_read_b32 v89, a73
    v_accvgpr_read_b32 v90, a74
    v_accvgpr_read_b32 v91, a75
    v_accvgpr_read_b32 v92, a76
    v_accvgpr_read_b32 v93, a77
    v_accvgpr_read_b32 v94, a78
    v_accvgpr_read_b32 v95, a79
    s_lshl_b32 s33, s29, 7
    s_lshl_b32 s34, s28, 5
    s_add_u32 s33, s33, s34
    v_and_b32 v10, 31, v1
    v_add_u32 v10, s33, v10
    v_mul_u32_u24 v7, 1280, v10
    v_lshrrev_b32 v11, 5, v1
    v_lshl_add_u32 v7, v11, 3, v7
    s_mul_i32 s33, s30, 320
    v_min_f32 v150, 0, v16
    v_min_f32 v151, 0, v17
    v_mul_f32 v150, 0x3fb8aa3b, v150
    v_mul_f32 v151, 0x3fb8aa3b, v151
    v_exp_f32 v150, v150
    v_exp_f32 v151, v151
    v_max_f32 v149, 0, v16
    v_max_f32 v148, 0, v17
    v_add_f32 v149, v149, v150
    v_add_f32 v148, v148, v151
    v_add_f32 v149, 0x358637bd, v149
    v_add_f32 v148, 0x358637bd, v148
    v_cvt_pk_bf16_f32 v144, v149, v148
    v_min_f32 v150, 0, v18
    v_min_f32 v151, 0, v19
    v_mul_f32 v150, 0x3fb8aa3b, v150
    v_mul_f32 v151, 0x3fb8aa3b, v151
    v_exp_f32 v150, v150
    v_exp_f32 v151, v151
    v_max_f32 v149, 0, v18
    v_max_f32 v148, 0, v19
    v_add_f32 v149, v149, v150
    v_add_f32 v148, v148, v151
    v_add_f32 v149, 0x358637bd, v149
    v_add_f32 v148, 0x358637bd, v148
    v_cvt_pk_bf16_f32 v145, v149, v148
    buffer_store_dwordx2 v[144:145], v7, s[16:19], s33 offen offset:0
    s_nop 1
    v_min_f32 v150, 0, v20
    v_min_f32 v151, 0, v21
    v_mul_f32 v150, 0x3fb8aa3b, v150
    v_mul_f32 v151, 0x3fb8aa3b, v151
    v_exp_f32 v150, v150
    v_exp_f32 v151, v151
    v_max_f32 v149, 0, v20
    v_max_f32 v148, 0, v21
    v_add_f32 v149, v149, v150
    v_add_f32 v148, v148, v151
    v_add_f32 v149, 0x358637bd, v149
    v_add_f32 v148, 0x358637bd, v148
    v_cvt_pk_bf16_f32 v144, v149, v148
    v_min_f32 v150, 0, v22
    v_min_f32 v151, 0, v23
    v_mul_f32 v150, 0x3fb8aa3b, v150
    v_mul_f32 v151, 0x3fb8aa3b, v151
    v_exp_f32 v150, v150
    v_exp_f32 v151, v151
    v_max_f32 v149, 0, v22
    v_max_f32 v148, 0, v23
    v_add_f32 v149, v149, v150
    v_add_f32 v148, v148, v151
    v_add_f32 v149, 0x358637bd, v149
    v_add_f32 v148, 0x358637bd, v148
    v_cvt_pk_bf16_f32 v145, v149, v148
    buffer_store_dwordx2 v[144:145], v7, s[16:19], s33 offen offset:16
    s_nop 1
    v_min_f32 v150, 0, v24
    v_min_f32 v151, 0, v25
    v_mul_f32 v150, 0x3fb8aa3b, v150
    v_mul_f32 v151, 0x3fb8aa3b, v151
    v_exp_f32 v150, v150
    v_exp_f32 v151, v151
    v_max_f32 v149, 0, v24
    v_max_f32 v148, 0, v25
    v_add_f32 v149, v149, v150
    v_add_f32 v148, v148, v151
    v_add_f32 v149, 0x358637bd, v149
    v_add_f32 v148, 0x358637bd, v148
    v_cvt_pk_bf16_f32 v144, v149, v148
    v_min_f32 v150, 0, v26
    v_min_f32 v151, 0, v27
    v_mul_f32 v150, 0x3fb8aa3b, v150
    v_mul_f32 v151, 0x3fb8aa3b, v151
    v_exp_f32 v150, v150
    v_exp_f32 v151, v151
    v_max_f32 v149, 0, v26
    v_max_f32 v148, 0, v27
    v_add_f32 v149, v149, v150
    v_add_f32 v148, v148, v151
    v_add_f32 v149, 0x358637bd, v149
    v_add_f32 v148, 0x358637bd, v148
    v_cvt_pk_bf16_f32 v145, v149, v148
    buffer_store_dwordx2 v[144:145], v7, s[16:19], s33 offen offset:32
    s_nop 1
    v_min_f32 v150, 0, v28
    v_min_f32 v151, 0, v29
    v_mul_f32 v150, 0x3fb8aa3b, v150
    v_mul_f32 v151, 0x3fb8aa3b, v151
    v_exp_f32 v150, v150
    v_exp_f32 v151, v151
    v_max_f32 v149, 0, v28
    v_max_f32 v148, 0, v29
    v_add_f32 v149, v149, v150
    v_add_f32 v148, v148, v151
    v_add_f32 v149, 0x358637bd, v149
    v_add_f32 v148, 0x358637bd, v148
    v_cvt_pk_bf16_f32 v144, v149, v148
    v_min_f32 v150, 0, v30
    v_min_f32 v151, 0, v31
    v_mul_f32 v150, 0x3fb8aa3b, v150
    v_mul_f32 v151, 0x3fb8aa3b, v151
    v_exp_f32 v150, v150
    v_exp_f32 v151, v151
    v_max_f32 v149, 0, v30
    v_max_f32 v148, 0, v31
    v_add_f32 v149, v149, v150
    v_add_f32 v148, v148, v151
    v_add_f32 v149, 0x358637bd, v149
    v_add_f32 v148, 0x358637bd, v148
    v_cvt_pk_bf16_f32 v145, v149, v148
    buffer_store_dwordx2 v[144:145], v7, s[16:19], s33 offen offset:48
    s_nop 1
    v_min_f32 v150, 0, v32
    v_min_f32 v151, 0, v33
    v_mul_f32 v150, 0x3fb8aa3b, v150
    v_mul_f32 v151, 0x3fb8aa3b, v151
    v_exp_f32 v150, v150
    v_exp_f32 v151, v151
    v_max_f32 v149, 0, v32
    v_max_f32 v148, 0, v33
    v_add_f32 v149, v149, v150
    v_add_f32 v148, v148, v151
    v_add_f32 v149, 0x358637bd, v149
    v_add_f32 v148, 0x358637bd, v148
    v_cvt_pk_bf16_f32 v144, v149, v148
    v_min_f32 v150, 0, v34
    v_min_f32 v151, 0, v35
    v_mul_f32 v150, 0x3fb8aa3b, v150
    v_mul_f32 v151, 0x3fb8aa3b, v151
    v_exp_f32 v150, v150
    v_exp_f32 v151, v151
    v_max_f32 v149, 0, v34
    v_max_f32 v148, 0, v35
    v_add_f32 v149, v149, v150
    v_add_f32 v148, v148, v151
    v_add_f32 v149, 0x358637bd, v149
    v_add_f32 v148, 0x358637bd, v148
    v_cvt_pk_bf16_f32 v145, v149, v148
    buffer_store_dwordx2 v[144:145], v7, s[16:19], s33 offen offset:64
    s_nop 1
    v_min_f32 v150, 0, v36
    v_min_f32 v151, 0, v37
    v_mul_f32 v150, 0x3fb8aa3b, v150
    v_mul_f32 v151, 0x3fb8aa3b, v151
    v_exp_f32 v150, v150
    v_exp_f32 v151, v151
    v_max_f32 v149, 0, v36
    v_max_f32 v148, 0, v37
    v_add_f32 v149, v149, v150
    v_add_f32 v148, v148, v151
    v_add_f32 v149, 0x358637bd, v149
    v_add_f32 v148, 0x358637bd, v148
    v_cvt_pk_bf16_f32 v144, v149, v148
    v_min_f32 v150, 0, v38
    v_min_f32 v151, 0, v39
    v_mul_f32 v150, 0x3fb8aa3b, v150
    v_mul_f32 v151, 0x3fb8aa3b, v151
    v_exp_f32 v150, v150
    v_exp_f32 v151, v151
    v_max_f32 v149, 0, v38
    v_max_f32 v148, 0, v39
    v_add_f32 v149, v149, v150
    v_add_f32 v148, v148, v151
    v_add_f32 v149, 0x358637bd, v149
    v_add_f32 v148, 0x358637bd, v148
    v_cvt_pk_bf16_f32 v145, v149, v148
    buffer_store_dwordx2 v[144:145], v7, s[16:19], s33 offen offset:80
    s_nop 1
    v_min_f32 v150, 0, v40
    v_min_f32 v151, 0, v41
    v_mul_f32 v150, 0x3fb8aa3b, v150
    v_mul_f32 v151, 0x3fb8aa3b, v151
    v_exp_f32 v150, v150
    v_exp_f32 v151, v151
    v_max_f32 v149, 0, v40
    v_max_f32 v148, 0, v41
    v_add_f32 v149, v149, v150
    v_add_f32 v148, v148, v151
    v_add_f32 v149, 0x358637bd, v149
    v_add_f32 v148, 0x358637bd, v148
    v_cvt_pk_bf16_f32 v144, v149, v148
    v_min_f32 v150, 0, v42
    v_min_f32 v151, 0, v43
    v_mul_f32 v150, 0x3fb8aa3b, v150
    v_mul_f32 v151, 0x3fb8aa3b, v151
    v_exp_f32 v150, v150
    v_exp_f32 v151, v151
    v_max_f32 v149, 0, v42
    v_max_f32 v148, 0, v43
    v_add_f32 v149, v149, v150
    v_add_f32 v148, v148, v151
    v_add_f32 v149, 0x358637bd, v149
    v_add_f32 v148, 0x358637bd, v148
    v_cvt_pk_bf16_f32 v145, v149, v148
    buffer_store_dwordx2 v[144:145], v7, s[16:19], s33 offen offset:96
    s_nop 1
    v_min_f32 v150, 0, v44
    v_min_f32 v151, 0, v45
    v_mul_f32 v150, 0x3fb8aa3b, v150
    v_mul_f32 v151, 0x3fb8aa3b, v151
    v_exp_f32 v150, v150
    v_exp_f32 v151, v151
    v_max_f32 v149, 0, v44
    v_max_f32 v148, 0, v45
    v_add_f32 v149, v149, v150
    v_add_f32 v148, v148, v151
    v_add_f32 v149, 0x358637bd, v149
    v_add_f32 v148, 0x358637bd, v148
    v_cvt_pk_bf16_f32 v144, v149, v148
    v_min_f32 v150, 0, v46
    v_min_f32 v151, 0, v47
    v_mul_f32 v150, 0x3fb8aa3b, v150
    v_mul_f32 v151, 0x3fb8aa3b, v151
    v_exp_f32 v150, v150
    v_exp_f32 v151, v151
    v_max_f32 v149, 0, v46
    v_max_f32 v148, 0, v47
    v_add_f32 v149, v149, v150
    v_add_f32 v148, v148, v151
    v_add_f32 v149, 0x358637bd, v149
    v_add_f32 v148, 0x358637bd, v148
    v_cvt_pk_bf16_f32 v145, v149, v148
    buffer_store_dwordx2 v[144:145], v7, s[16:19], s33 offen offset:112
    s_nop 1
    v_min_f32 v150, 0, v48
    v_min_f32 v151, 0, v49
    v_mul_f32 v150, 0x3fb8aa3b, v150
    v_mul_f32 v151, 0x3fb8aa3b, v151
    v_exp_f32 v150, v150
    v_exp_f32 v151, v151
    v_max_f32 v149, 0, v48
    v_max_f32 v148, 0, v49
    v_add_f32 v149, v149, v150
    v_add_f32 v148, v148, v151
    v_add_f32 v149, 0x358637bd, v149
    v_add_f32 v148, 0x358637bd, v148
    v_cvt_pk_bf16_f32 v144, v149, v148
    v_min_f32 v150, 0, v50
    v_min_f32 v151, 0, v51
    v_mul_f32 v150, 0x3fb8aa3b, v150
    v_mul_f32 v151, 0x3fb8aa3b, v151
    v_exp_f32 v150, v150
    v_exp_f32 v151, v151
    v_max_f32 v149, 0, v50
    v_max_f32 v148, 0, v51
    v_add_f32 v149, v149, v150
    v_add_f32 v148, v148, v151
    v_add_f32 v149, 0x358637bd, v149
    v_add_f32 v148, 0x358637bd, v148
    v_cvt_pk_bf16_f32 v145, v149, v148
    buffer_store_dwordx2 v[144:145], v7, s[16:19], s33 offen offset:128
    s_nop 1
    v_min_f32 v150, 0, v52
    v_min_f32 v151, 0, v53
    v_mul_f32 v150, 0x3fb8aa3b, v150
    v_mul_f32 v151, 0x3fb8aa3b, v151
    v_exp_f32 v150, v150
    v_exp_f32 v151, v151
    v_max_f32 v149, 0, v52
    v_max_f32 v148, 0, v53
    v_add_f32 v149, v149, v150
    v_add_f32 v148, v148, v151
    v_add_f32 v149, 0x358637bd, v149
    v_add_f32 v148, 0x358637bd, v148
    v_cvt_pk_bf16_f32 v144, v149, v148
    v_min_f32 v150, 0, v54
    v_min_f32 v151, 0, v55
    v_mul_f32 v150, 0x3fb8aa3b, v150
    v_mul_f32 v151, 0x3fb8aa3b, v151
    v_exp_f32 v150, v150
    v_exp_f32 v151, v151
    v_max_f32 v149, 0, v54
    v_max_f32 v148, 0, v55
    v_add_f32 v149, v149, v150
    v_add_f32 v148, v148, v151
    v_add_f32 v149, 0x358637bd, v149
    v_add_f32 v148, 0x358637bd, v148
    v_cvt_pk_bf16_f32 v145, v149, v148
    buffer_store_dwordx2 v[144:145], v7, s[16:19], s33 offen offset:144
    s_nop 1
    v_min_f32 v150, 0, v56
    v_min_f32 v151, 0, v57
    v_mul_f32 v150, 0x3fb8aa3b, v150
    v_mul_f32 v151, 0x3fb8aa3b, v151
    v_exp_f32 v150, v150
    v_exp_f32 v151, v151
    v_max_f32 v149, 0, v56
    v_max_f32 v148, 0, v57
    v_add_f32 v149, v149, v150
    v_add_f32 v148, v148, v151
    v_add_f32 v149, 0x358637bd, v149
    v_add_f32 v148, 0x358637bd, v148
    v_cvt_pk_bf16_f32 v144, v149, v148
    v_min_f32 v150, 0, v58
    v_min_f32 v151, 0, v59
    v_mul_f32 v150, 0x3fb8aa3b, v150
    v_mul_f32 v151, 0x3fb8aa3b, v151
    v_exp_f32 v150, v150
    v_exp_f32 v151, v151
    v_max_f32 v149, 0, v58
    v_max_f32 v148, 0, v59
    v_add_f32 v149, v149, v150
    v_add_f32 v148, v148, v151
    v_add_f32 v149, 0x358637bd, v149
    v_add_f32 v148, 0x358637bd, v148
    v_cvt_pk_bf16_f32 v145, v149, v148
    buffer_store_dwordx2 v[144:145], v7, s[16:19], s33 offen offset:160
    s_nop 1
    v_min_f32 v150, 0, v60
    v_min_f32 v151, 0, v61
    v_mul_f32 v150, 0x3fb8aa3b, v150
    v_mul_f32 v151, 0x3fb8aa3b, v151
    v_exp_f32 v150, v150
    v_exp_f32 v151, v151
    v_max_f32 v149, 0, v60
    v_max_f32 v148, 0, v61
    v_add_f32 v149, v149, v150
    v_add_f32 v148, v148, v151
    v_add_f32 v149, 0x358637bd, v149
    v_add_f32 v148, 0x358637bd, v148
    v_cvt_pk_bf16_f32 v144, v149, v148
    v_min_f32 v150, 0, v62
    v_min_f32 v151, 0, v63
    v_mul_f32 v150, 0x3fb8aa3b, v150
    v_mul_f32 v151, 0x3fb8aa3b, v151
    v_exp_f32 v150, v150
    v_exp_f32 v151, v151
    v_max_f32 v149, 0, v62
    v_max_f32 v148, 0, v63
    v_add_f32 v149, v149, v150
    v_add_f32 v148, v148, v151
    v_add_f32 v149, 0x358637bd, v149
    v_add_f32 v148, 0x358637bd, v148
    v_cvt_pk_bf16_f32 v145, v149, v148
    buffer_store_dwordx2 v[144:145], v7, s[16:19], s33 offen offset:176
    s_nop 1
    v_min_f32 v150, 0, v64
    v_min_f32 v151, 0, v65
    v_mul_f32 v150, 0x3fb8aa3b, v150
    v_mul_f32 v151, 0x3fb8aa3b, v151
    v_exp_f32 v150, v150
    v_exp_f32 v151, v151
    v_max_f32 v149, 0, v64
    v_max_f32 v148, 0, v65
    v_add_f32 v149, v149, v150
    v_add_f32 v148, v148, v151
    v_add_f32 v149, 0x358637bd, v149
    v_add_f32 v148, 0x358637bd, v148
    v_cvt_pk_bf16_f32 v144, v149, v148
    v_min_f32 v150, 0, v66
    v_min_f32 v151, 0, v67
    v_mul_f32 v150, 0x3fb8aa3b, v150
    v_mul_f32 v151, 0x3fb8aa3b, v151
    v_exp_f32 v150, v150
    v_exp_f32 v151, v151
    v_max_f32 v149, 0, v66
    v_max_f32 v148, 0, v67
    v_add_f32 v149, v149, v150
    v_add_f32 v148, v148, v151
    v_add_f32 v149, 0x358637bd, v149
    v_add_f32 v148, 0x358637bd, v148
    v_cvt_pk_bf16_f32 v145, v149, v148
    buffer_store_dwordx2 v[144:145], v7, s[16:19], s33 offen offset:192
    s_nop 1
    v_min_f32 v150, 0, v68
    v_min_f32 v151, 0, v69
    v_mul_f32 v150, 0x3fb8aa3b, v150
    v_mul_f32 v151, 0x3fb8aa3b, v151
    v_exp_f32 v150, v150
    v_exp_f32 v151, v151
    v_max_f32 v149, 0, v68
    v_max_f32 v148, 0, v69
    v_add_f32 v149, v149, v150
    v_add_f32 v148, v148, v151
    v_add_f32 v149, 0x358637bd, v149
    v_add_f32 v148, 0x358637bd, v148
    v_cvt_pk_bf16_f32 v144, v149, v148
    v_min_f32 v150, 0, v70
    v_min_f32 v151, 0, v71
    v_mul_f32 v150, 0x3fb8aa3b, v150
    v_mul_f32 v151, 0x3fb8aa3b, v151
    v_exp_f32 v150, v150
    v_exp_f32 v151, v151
    v_max_f32 v149, 0, v70
    v_max_f32 v148, 0, v71
    v_add_f32 v149, v149, v150
    v_add_f32 v148, v148, v151
    v_add_f32 v149, 0x358637bd, v149
    v_add_f32 v148, 0x358637bd, v148
    v_cvt_pk_bf16_f32 v145, v149, v148
    buffer_store_dwordx2 v[144:145], v7, s[16:19], s33 offen offset:208
    s_nop 1
    v_min_f32 v150, 0, v72
    v_min_f32 v151, 0, v73
    v_mul_f32 v150, 0x3fb8aa3b, v150
    v_mul_f32 v151, 0x3fb8aa3b, v151
    v_exp_f32 v150, v150
    v_exp_f32 v151, v151
    v_max_f32 v149, 0, v72
    v_max_f32 v148, 0, v73
    v_add_f32 v149, v149, v150
    v_add_f32 v148, v148, v151
    v_add_f32 v149, 0x358637bd, v149
    v_add_f32 v148, 0x358637bd, v148
    v_cvt_pk_bf16_f32 v144, v149, v148
    v_min_f32 v150, 0, v74
    v_min_f32 v151, 0, v75
    v_mul_f32 v150, 0x3fb8aa3b, v150
    v_mul_f32 v151, 0x3fb8aa3b, v151
    v_exp_f32 v150, v150
    v_exp_f32 v151, v151
    v_max_f32 v149, 0, v74
    v_max_f32 v148, 0, v75
    v_add_f32 v149, v149, v150
    v_add_f32 v148, v148, v151
    v_add_f32 v149, 0x358637bd, v149
    v_add_f32 v148, 0x358637bd, v148
    v_cvt_pk_bf16_f32 v145, v149, v148
    buffer_store_dwordx2 v[144:145], v7, s[16:19], s33 offen offset:224
    s_nop 1
    v_min_f32 v150, 0, v76
    v_min_f32 v151, 0, v77
    v_mul_f32 v150, 0x3fb8aa3b, v150
    v_mul_f32 v151, 0x3fb8aa3b, v151
    v_exp_f32 v150, v150
    v_exp_f32 v151, v151
    v_max_f32 v149, 0, v76
    v_max_f32 v148, 0, v77
    v_add_f32 v149, v149, v150
    v_add_f32 v148, v148, v151
    v_add_f32 v149, 0x358637bd, v149
    v_add_f32 v148, 0x358637bd, v148
    v_cvt_pk_bf16_f32 v144, v149, v148
    v_min_f32 v150, 0, v78
    v_min_f32 v151, 0, v79
    v_mul_f32 v150, 0x3fb8aa3b, v150
    v_mul_f32 v151, 0x3fb8aa3b, v151
    v_exp_f32 v150, v150
    v_exp_f32 v151, v151
    v_max_f32 v149, 0, v78
    v_max_f32 v148, 0, v79
    v_add_f32 v149, v149, v150
    v_add_f32 v148, v148, v151
    v_add_f32 v149, 0x358637bd, v149
    v_add_f32 v148, 0x358637bd, v148
    v_cvt_pk_bf16_f32 v145, v149, v148
    buffer_store_dwordx2 v[144:145], v7, s[16:19], s33 offen offset:240
    s_nop 1
    v_min_f32 v150, 0, v80
    v_min_f32 v151, 0, v81
    v_mul_f32 v150, 0x3fb8aa3b, v150
    v_mul_f32 v151, 0x3fb8aa3b, v151
    v_exp_f32 v150, v150
    v_exp_f32 v151, v151
    v_max_f32 v149, 0, v80
    v_max_f32 v148, 0, v81
    v_add_f32 v149, v149, v150
    v_add_f32 v148, v148, v151
    v_add_f32 v149, 0x358637bd, v149
    v_add_f32 v148, 0x358637bd, v148
    v_cvt_pk_bf16_f32 v144, v149, v148
    v_min_f32 v150, 0, v82
    v_min_f32 v151, 0, v83
    v_mul_f32 v150, 0x3fb8aa3b, v150
    v_mul_f32 v151, 0x3fb8aa3b, v151
    v_exp_f32 v150, v150
    v_exp_f32 v151, v151
    v_max_f32 v149, 0, v82
    v_max_f32 v148, 0, v83
    v_add_f32 v149, v149, v150
    v_add_f32 v148, v148, v151
    v_add_f32 v149, 0x358637bd, v149
    v_add_f32 v148, 0x358637bd, v148
    v_cvt_pk_bf16_f32 v145, v149, v148
    buffer_store_dwordx2 v[144:145], v7, s[16:19], s33 offen offset:256
    s_nop 1
    v_min_f32 v150, 0, v84
    v_min_f32 v151, 0, v85
    v_mul_f32 v150, 0x3fb8aa3b, v150
    v_mul_f32 v151, 0x3fb8aa3b, v151
    v_exp_f32 v150, v150
    v_exp_f32 v151, v151
    v_max_f32 v149, 0, v84
    v_max_f32 v148, 0, v85
    v_add_f32 v149, v149, v150
    v_add_f32 v148, v148, v151
    v_add_f32 v149, 0x358637bd, v149
    v_add_f32 v148, 0x358637bd, v148
    v_cvt_pk_bf16_f32 v144, v149, v148
    v_min_f32 v150, 0, v86
    v_min_f32 v151, 0, v87
    v_mul_f32 v150, 0x3fb8aa3b, v150
    v_mul_f32 v151, 0x3fb8aa3b, v151
    v_exp_f32 v150, v150
    v_exp_f32 v151, v151
    v_max_f32 v149, 0, v86
    v_max_f32 v148, 0, v87
    v_add_f32 v149, v149, v150
    v_add_f32 v148, v148, v151
    v_add_f32 v149, 0x358637bd, v149
    v_add_f32 v148, 0x358637bd, v148
    v_cvt_pk_bf16_f32 v145, v149, v148
    buffer_store_dwordx2 v[144:145], v7, s[16:19], s33 offen offset:272
    s_nop 1
    v_min_f32 v150, 0, v88
    v_min_f32 v151, 0, v89
    v_mul_f32 v150, 0x3fb8aa3b, v150
    v_mul_f32 v151, 0x3fb8aa3b, v151
    v_exp_f32 v150, v150
    v_exp_f32 v151, v151
    v_max_f32 v149, 0, v88
    v_max_f32 v148, 0, v89
    v_add_f32 v149, v149, v150
    v_add_f32 v148, v148, v151
    v_add_f32 v149, 0x358637bd, v149
    v_add_f32 v148, 0x358637bd, v148
    v_cvt_pk_bf16_f32 v144, v149, v148
    v_min_f32 v150, 0, v90
    v_min_f32 v151, 0, v91
    v_mul_f32 v150, 0x3fb8aa3b, v150
    v_mul_f32 v151, 0x3fb8aa3b, v151
    v_exp_f32 v150, v150
    v_exp_f32 v151, v151
    v_max_f32 v149, 0, v90
    v_max_f32 v148, 0, v91
    v_add_f32 v149, v149, v150
    v_add_f32 v148, v148, v151
    v_add_f32 v149, 0x358637bd, v149
    v_add_f32 v148, 0x358637bd, v148
    v_cvt_pk_bf16_f32 v145, v149, v148
    buffer_store_dwordx2 v[144:145], v7, s[16:19], s33 offen offset:288
    s_nop 1
    v_min_f32 v150, 0, v92
    v_min_f32 v151, 0, v93
    v_mul_f32 v150, 0x3fb8aa3b, v150
    v_mul_f32 v151, 0x3fb8aa3b, v151
    v_exp_f32 v150, v150
    v_exp_f32 v151, v151
    v_max_f32 v149, 0, v92
    v_max_f32 v148, 0, v93
    v_add_f32 v149, v149, v150
    v_add_f32 v148, v148, v151
    v_add_f32 v149, 0x358637bd, v149
    v_add_f32 v148, 0x358637bd, v148
    v_cvt_pk_bf16_f32 v144, v149, v148
    v_min_f32 v150, 0, v94
    v_min_f32 v151, 0, v95
    v_mul_f32 v150, 0x3fb8aa3b, v150
    v_mul_f32 v151, 0x3fb8aa3b, v151
    v_exp_f32 v150, v150
    v_exp_f32 v151, v151
    v_max_f32 v149, 0, v94
    v_max_f32 v148, 0, v95
    v_add_f32 v149, v149, v150
    v_add_f32 v148, v148, v151
    v_add_f32 v149, 0x358637bd, v149
    v_add_f32 v148, 0x358637bd, v148
    v_cvt_pk_bf16_f32 v145, v149, v148
    buffer_store_dwordx2 v[144:145], v7, s[16:19], s33 offen offset:304
    s_nop 1
K1_END:
    s_endpgm
.globl linear_attn_out_kernel
.p2align 8
.type linear_attn_out_kernel,@function
linear_attn_out_kernel:
    s_cmp_ge_u32 s2, 256
    s_cbranch_scc1 K2_END
    s_load_dwordx4 s[4:7], s[0:1], 16
    s_load_dwordx4 s[24:27], s[0:1], 32
    v_and_b32 v1, 63, v0
    v_lshrrev_b32 v2, 6, v0
    s_nop 0
    v_readfirstlane_b32 s28, v2
    v_and_b32 v10, 15, v1
    v_lshrrev_b32 v11, 4, v1
    v_mov_b32 v15, 0x7ffffff0
    s_waitcnt lgkmcnt(0)
    s_mov_b32 s8, s4
    s_mov_b32 s9, s5
    s_mov_b32 s10, 0xc8000
    s_mov_b32 s11, 0x00020000
    s_mov_b32 s12, s6
    s_mov_b32 s13, s7
    s_mov_b32 s14, 0x280000
    s_mov_b32 s15, 0x00020000
    s_mov_b32 s16, s26
    s_mov_b32 s17, s27
    s_mov_b32 s18, 0x280000
    s_mov_b32 s19, 0x00020000
    s_add_u32 s20, s26, 0x300000
    s_addc_u32 s21, s27, 0
    s_mov_b32 s22, 0xd200
    s_mov_b32 s23, 0x00020000
    s_and_b32 s33, s2, 7
    s_lshr_b32 s34, s2, 3
    s_and_b32 s29, s33, 3
    s_lshl_b32 s29, s29, 3
    s_and_b32 s35, s34, 7
    s_add_u32 s29, s29, s35
    s_lshr_b32 s30, s33, 2
    s_lshl_b32 s30, s30, 2
    s_lshr_b32 s34, s34, 3
    s_add_u32 s30, s30, s34
    s_mul_i32 s36, s28, 6400
    s_mul_i32 s37, s28, 320
    s_add_u32 s37, s37, 51200
    s_mul_i32 s38, s28, 160
    s_mul_i32 s46, s28, 7168
    s_add_u32 s46, s46, 106496
    v_lshlrev_b32 v2, 4, v1
    s_add_u32 m0, s46, 0
    s_add_u32 s39, s36, 0
    buffer_load_dwordx4 v2, s[20:23], s39 offen lds
    s_add_u32 m0, s46, 1024
    s_add_u32 s39, s36, 1024
    buffer_load_dwordx4 v2, s[20:23], s39 offen lds
    s_add_u32 m0, s46, 2048
    s_add_u32 s39, s36, 2048
    buffer_load_dwordx4 v2, s[20:23], s39 offen lds
    s_add_u32 m0, s46, 3072
    s_add_u32 s39, s36, 3072
    buffer_load_dwordx4 v2, s[20:23], s39 offen lds
    s_add_u32 m0, s46, 4096
    s_add_u32 s39, s36, 4096
    buffer_load_dwordx4 v2, s[20:23], s39 offen lds
    s_add_u32 m0, s46, 5120
    s_add_u32 s39, s36, 5120
    buffer_load_dwordx4 v2, s[20:23], s39 offen lds
    v_add_u32 v3, s36, v2
    v_add_u32 v3, 6144, v3
    v_add_u32 v4, s37, v2
    v_add_u32 v4, -256, v4
    v_cmp_gt_u32 vcc, 16, v1
    s_nop 1
    v_cndmask_b32 v3, v4, v3, vcc
    v_cmp_gt_u32 vcc, 36, v1
    s_nop 1
    v_cndmask_b32 v3, v15, v3, vcc
    s_add_u32 m0, s46, 6144
    s_nop 0
    buffer_load_dwordx4 v3, s[20:23], 0 offen lds
    s_lshl_b32 s33, s29, 6
    v_add_u32 v12, s33, v10
    v_mul_u32_u24 v9, 1280, v12
    v_lshl_add_u32 v9, v11, 4, v9
    s_add_u32 s39, s38, 0
    buffer_load_dwordx4 a[0:3], v9, s[16:19], s39 offen offset:0
    buffer_load_dwordx4 a[4:7], v9, s[16:19], s39 offen offset:64
    buffer_load_dwordx4 a[8:11], v9, s[16:19], s39 offen offset:128
    s_add_u32 s39, s38, 20480
    buffer_load_dwordx4 a[12:15], v9, s[16:19], s39 offen offset:0
    buffer_load_dwordx4 a[16:19], v9, s[16:19], s39 offen offset:64
    buffer_load_dwordx4 a[20:23], v9, s[16:19], s39 offen offset:128
    s_add_u32 s39, s38, 40960
    buffer_load_dwordx4 a[24:27], v9, s[16:19], s39 offen offset:0
    buffer_load_dwordx4 a[28:31], v9, s[16:19], s39 offen offset:64
    buffer_load_dwordx4 a[32:35], v9, s[16:19], s39 offen offset:128
    s_add_u32 s39, s38, 61440
    buffer_load_dwordx4 a[36:39], v9, s[16:19], s39 offen offset:0
    buffer_load_dwordx4 a[40:43], v9, s[16:19], s39 offen offset:64
    buffer_load_dwordx4 a[44:47], v9, s[16:19], s39 offen offset:128
    s_mul_i32 s33, s28, 80*1280
    s_mul_i32 s34, s30, 160
    s_add_u32 s33, s33, s34
    s_movk_i32 s34, 6554
    v_add_u32 v2, 0, v1
    v_mul_u32_u24 v3, s34, v2
    v_lshrrev_b32 v3, 16, v3
    v_mul_u32_u24 v4, 10, v3
    v_sub_u32 v4, v2, v4
    v_mul_u32_u24 v5, 1280, v3
    v_lshl_add_u32 v5, v4, 4, v5
    v_add_u32 v160, s33, v5
    v_add_u32 v2, 64, v1
    v_mul_u32_u24 v3, s34, v2
    v_lshrrev_b32 v3, 16, v3
    v_mul_u32_u24 v4, 10, v3
    v_sub_u32 v4, v2, v4
    v_mul_u32_u24 v5, 1280, v3
    v_lshl_add_u32 v5, v4, 4, v5
    v_add_u32 v161, s33, v5
    v_add_u32 v2, 128, v1
    v_mul_u32_u24 v3, s34, v2
    v_lshrrev_b32 v3, 16, v3
    v_mul_u32_u24 v4, 10, v3
    v_sub_u32 v4, v2, v4
    v_mul_u32_u24 v5, 1280, v3
    v_lshl_add_u32 v5, v4, 4, v5
    v_add_u32 v162, s33, v5
    v_add_u32 v2, 192, v1
    v_mul_u32_u24 v3, s34, v2
    v_lshrrev_b32 v3, 16, v3
    v_mul_u32_u24 v4, 10, v3
    v_sub_u32 v4, v2, v4
    v_mul_u32_u24 v5, 1280, v3
    v_lshl_add_u32 v5, v4, 4, v5
    v_add_u32 v163, s33, v5
    v_add_u32 v2, 256, v1
    v_mul_u32_u24 v3, s34, v2
    v_lshrrev_b32 v3, 16, v3
    v_mul_u32_u24 v4, 10, v3
    v_sub_u32 v4, v2, v4
    v_mul_u32_u24 v5, 1280, v3
    v_lshl_add_u32 v5, v4, 4, v5
    v_add_u32 v164, s33, v5
    s_mul_i32 s35, s28, 13312
    s_add_u32 m0, s35, 0
    s_mov_b32 s39, 0
    buffer_load_dwordx4 v160, s[8:11], s39 offen lds
    s_add_u32 m0, s35, 1024
    s_mov_b32 s39, 0
    buffer_load_dwordx4 v161, s[8:11], s39 offen lds
    s_add_u32 m0, s35, 2048
    s_mov_b32 s39, 0
    buffer_load_dwordx4 v162, s[8:11], s39 offen lds
    s_add_u32 m0, s35, 3072
    s_mov_b32 s39, 0
    buffer_load_dwordx4 v163, s[8:11], s39 offen lds
    s_add_u32 m0, s35, 4096
    s_mov_b32 s39, 0
    buffer_load_dwordx4 v164, s[8:11], s39 offen lds
    s_add_u32 m0, s35, 5120
    s_mov_b32 s39, 40960
    buffer_load_dwordx4 v160, s[8:11], s39 offen lds
    s_add_u32 m0, s35, 6144
    s_mov_b32 s39, 40960
    buffer_load_dwordx4 v161, s[8:11], s39 offen lds
    s_add_u32 m0, s35, 7168
    s_mov_b32 s39, 40960
    buffer_load_dwordx4 v162, s[8:11], s39 offen lds
    s_add_u32 m0, s35, 8192
    s_mov_b32 s39, 40960
    buffer_load_dwordx4 v163, s[8:11], s39 offen lds
    s_add_u32 m0, s35, 9216
    s_mov_b32 s39, 40960
    buffer_load_dwordx4 v164, s[8:11], s39 offen lds
    s_add_u32 m0, s35, 10240
    s_mov_b32 s39, 81920
    buffer_load_dwordx4 v160, s[8:11], s39 offen lds
    s_add_u32 m0, s35, 11264
    s_mov_b32 s39, 81920
    buffer_load_dwordx4 v161, s[8:11], s39 offen lds
    s_add_u32 m0, s35, 12288
    s_mov_b32 s39, 81920
    buffer_load_dwordx4 v162, s[8:11], s39 offen lds
    v_cmp_eq_u32 s[40:41], 0, v11
    v_cmp_gt_u32 s[42:43], 2, v11
    v_cmp_gt_u32 s[44:45], 3, v11
    v_mov_b32 v194, 0
    v_mov_b32 v195, 0
    v_mov_b32 v198, 0
    v_mov_b32 v199, 0
    v_mov_b32 v202, 0
    v_mov_b32 v203, 0
    v_mov_b32 v206, 0
    v_mov_b32 v207, 0
    s_waitcnt vmcnt(25)
    v_mov_b32 v14, 6720
    v_add_u32 v2, 0, v10
    v_mul_u32_u24 v3, 3277, v2
    v_lshrrev_b32 v3, 16, v3
    v_mul_u32_u24 v3, 20, v3
    v_mul_u32_u24 v2, 20, v2
    v_sub_u32 v7, v2, v3
    v_lshlrev_b32 v8, 3, v11
    v_sub_u32 v8, v8, v3
    v_add_u32 v4, 0, v8
    v_lshlrev_b32 v5, 3, v11
    v_add3_u32 v5, v5, v7, 0
    v_lshlrev_b32 v5, 2, v5
    v_cmp_gt_u32 vcc, 20, v4
    v_add_u32 v6, 16, v5
    v_add_u32 v4, 4, v4
    v_cndmask_b32 v5, v14, v5, vcc
    v_cmp_gt_u32 vcc, 20, v4
    v_add_u32 v5, s46, v5
    s_nop 0
    v_cndmask_b32 v6, v14, v6, vcc
    v_add_u32 v6, s46, v6
    ds_read_b128 v[16:19], v5
    ds_read_b128 v[20:23], v6
    v_add_u32 v2, 16, v10
    v_mul_u32_u24 v3, 3277, v2
    v_lshrrev_b32 v3, 16, v3
    v_mul_u32_u24 v3, 20, v3
    v_mul_u32_u24 v2, 20, v2
    v_sub_u32 v7, v2, v3
    v_lshlrev_b32 v8, 3, v11
    v_sub_u32 v8, v8, v3
    v_add_u32 v4, 0, v8
    v_lshlrev_b32 v5, 3, v11
    v_add3_u32 v5, v5, v7, 0
    v_lshlrev_b32 v5, 2, v5
    v_cmp_gt_u32 vcc, 20, v4
    v_add_u32 v6, 16, v5
    v_add_u32 v4, 4, v4
    v_cndmask_b32 v5, v14, v5, vcc
    v_cmp_gt_u32 vcc, 20, v4
    v_add_u32 v5, s46, v5
    s_nop 0
    v_cndmask_b32 v6, v14, v6, vcc
    v_add_u32 v6, s46, v6
    ds_read_b128 v[24:27], v5
    ds_read_b128 v[28:31], v6
    v_add_u32 v4, 32, v8
    v_lshlrev_b32 v5, 3, v11
    v_add3_u32 v5, v5, v7, 32
    v_lshlrev_b32 v5, 2, v5
    v_cmp_gt_u32 vcc, 20, v4
    v_add_u32 v6, 16, v5
    v_add_u32 v4, 4, v4
    v_cndmask_b32 v5, v14, v5, vcc
    v_cmp_gt_u32 vcc, 20, v4
    v_add_u32 v5, s46, v5
    s_nop 0
    v_cndmask_b32 v6, v14, v6, vcc
    v_add_u32 v6, s46, v6
    ds_read_b128 v[32:35], v5
    ds_read_b128 v[36:39], v6
    v_add_u32 v2, 32, v10
    v_mul_u32_u24 v3, 3277, v2
    v_lshrrev_b32 v3, 16, v3
    v_mul_u32_u24 v3, 20, v3
    v_mul_u32_u24 v2, 20, v2
    v_sub_u32 v7, v2, v3
    v_lshlrev_b32 v8, 3, v11
    v_sub_u32 v8, v8, v3
    v_add_u32 v4, 0, v8
    v_lshlrev_b32 v5, 3, v11
    v_add3_u32 v5, v5, v7, 0
    v_lshlrev_b32 v5, 2, v5
    v_cmp_gt_u32 vcc, 20, v4
    v_add_u32 v6, 16, v5
    v_add_u32 v4, 4, v4
    v_cndmask_b32 v5, v14, v5, vcc
    v_cmp_gt_u32 vcc, 20, v4
    v_add_u32 v5, s46, v5
    s_nop 0
    v_cndmask_b32 v6, v14, v6, vcc
    v_add_u32 v6, s46, v6
    ds_read_b128 v[40:43], v5
    ds_read_b128 v[44:47], v6
    v_add_u32 v4, 32, v8
    v_lshlrev_b32 v5, 3, v11
    v_add3_u32 v5, v5, v7, 32
    v_lshlrev_b32 v5, 2, v5
    v_cmp_gt_u32 vcc, 20, v4
    v_add_u32 v6, 16, v5
    v_add_u32 v4, 4, v4
    v_cndmask_b32 v5, v14, v5, vcc
    v_cmp_gt_u32 vcc, 20, v4
    v_add_u32 v5, s46, v5
    s_nop 0
    v_cndmask_b32 v6, v14, v6, vcc
    v_add_u32 v6, s46, v6
    ds_read_b128 v[48:51], v5
    ds_read_b128 v[52:55], v6
    v_add_u32 v2, 48, v10
    v_mul_u32_u24 v3, 3277, v2
    v_lshrrev_b32 v3, 16, v3
    v_mul_u32_u24 v3, 20, v3
    v_mul_u32_u24 v2, 20, v2
    v_sub_u32 v7, v2, v3
    v_lshlrev_b32 v8, 3, v11
    v_sub_u32 v8, v8, v3
    v_add_u32 v4, 32, v8
    v_lshlrev_b32 v5, 3, v11
    v_add3_u32 v5, v5, v7, 32
    v_lshlrev_b32 v5, 2, v5
    v_cmp_gt_u32 vcc, 20, v4
    v_add_u32 v6, 16, v5
    v_add_u32 v4, 4, v4
    v_cndmask_b32 v5, v14, v5, vcc
    v_cmp_gt_u32 vcc, 20, v4
    v_add_u32 v5, s46, v5
    s_nop 0
    v_cndmask_b32 v6, v14, v6, vcc
    v_add_u32 v6, s46, v6
    ds_read_b128 v[56:59], v5
    ds_read_b128 v[60:63], v6
    v_add_u32 v4, 64, v8
    v_lshlrev_b32 v5, 3, v11
    v_add3_u32 v5, v5, v7, 64
    v_lshlrev_b32 v5, 2, v5
    v_cmp_gt_u32 vcc, 20, v4
    v_add_u32 v6, 16, v5
    v_add_u32 v4, 4, v4
    v_cndmask_b32 v5, v14, v5, vcc
    v_cmp_gt_u32 vcc, 20, v4
    v_add_u32 v5, s46, v5
    s_nop 0
    v_cndmask_b32 v6, v14, v6, vcc
    v_add_u32 v6, s46, v6
    ds_read_b128 v[64:67], v5
    ds_read_b128 v[68:71], v6
    v_add_u32 v2, 64, v10
    v_mul_u32_u24 v3, 3277, v2
    v_lshrrev_b32 v3, 16, v3
    v_mul_u32_u24 v3, 20, v3
    v_mul_u32_u24 v2, 20, v2
    v_sub_u32 v7, v2, v3
    v_lshlrev_b32 v8, 3, v11
    v_sub_u32 v8, v8, v3
    v_add_u32 v4, 32, v8
    v_lshlrev_b32 v5, 3, v11
    v_add3_u32 v5, v5, v7, 32
    v_lshlrev_b32 v5, 2, v5
    v_cmp_gt_u32 vcc, 20, v4
    v_add_u32 v6, 16, v5
    v_add_u32 v4, 4, v4
    v_cndmask_b32 v5, v14, v5, vcc
    v_cmp_gt_u32 vcc, 20, v4
    v_add_u32 v5, s46, v5
    s_nop 0
    v_cndmask_b32 v6, v14, v6, vcc
    v_add_u32 v6, s46, v6
    ds_read_b128 v[72:75], v5
    ds_read_b128 v[76:79], v6
    v_add_u32 v4, 64, v8
    v_lshlrev_b32 v5, 3, v11
    v_add3_u32 v5, v5, v7, 64
    v_lshlrev_b32 v5, 2, v5
    v_cmp_gt_u32 vcc, 20, v4
    v_add_u32 v6, 16, v5
    v_add_u32 v4, 4, v4
    v_cndmask_b32 v5, v14, v5, vcc
    v_cmp_gt_u32 vcc, 20, v4
    v_add_u32 v5, s46, v5
    s_nop 0
    v_cndmask_b32 v6, v14, v6, vcc
    v_add_u32 v6, s46, v6
    ds_read_b128 v[80:83], v5
    ds_read_b128 v[84:87], v6
    v_and_b32 v3, 3, v10
    v_mul_u32_u24 v3, 20, v3
    v_mov_b32 v7, 1600
    v_lshlrev_b32 v8, 3, v11
    v_sub_u32 v8, v8, v3
    v_add_u32 v4, 0, v8
    v_lshlrev_b32 v5, 3, v11
    v_add3_u32 v5, v5, v7, 0
    v_lshlrev_b32 v5, 2, v5
    v_cmp_gt_u32 vcc, 20, v4
    v_add_u32 v6, 16, v5
    v_add_u32 v4, 4, v4
    v_cndmask_b32 v5, v14, v5, vcc
    v_cmp_gt_u32 vcc, 20, v4
    v_add_u32 v5, s46, v5
    s_nop 0
    v_cndmask_b32 v6, v14, v6, vcc
    v_add_u32 v6, s46, v6
    ds_read_b128 v[88:91], v5
    ds_read_b128 v[92:95], v6
    v_add_u32 v4, 32, v8
    v_lshlrev_b32 v5, 3, v11
    v_add3_u32 v5, v5, v7, 32
    v_lshlrev_b32 v5, 2, v5
    v_cmp_gt_u32 vcc, 20, v4
    v_add_u32 v6, 16, v5
    v_add_u32 v4, 4, v4
    v_cndmask_b32 v5, v14, v5, vcc
    v_cmp_gt_u32 vcc, 20, v4
    v_add_u32 v5, s46, v5
    s_nop 0
    v_cndmask_b32 v6, v14, v6, vcc
    v_add_u32 v6, s46, v6
    ds_read_b128 v[96:99], v5
    ds_read_b128 v[100:103], v6
    v_add_u32 v4, 64, v8
    v_lshlrev_b32 v5, 3, v11
    v_add3_u32 v5, v5, v7, 64
    v_lshlrev_b32 v5, 2, v5
    v_cmp_gt_u32 vcc, 20, v4
    v_add_u32 v6, 16, v5
    v_add_u32 v4, 4, v4
    v_cndmask_b32 v5, v14, v5, vcc
    v_cmp_gt_u32 vcc, 20, v4
    v_add_u32 v5, s46, v5
    s_nop 0
    v_cndmask_b32 v6, v14, v6, vcc
    v_add_u32 v6, s46, v6
    ds_read_b128 v[104:107], v5
    ds_read_b128 v[108:111], v6
    s_waitcnt lgkmcnt(0)
    v_cvt_pk_bf16_f32 v112, v16, v17
    v_cvt_pk_bf16_f32 v113, v18, v19
    v_cvt_pk_bf16_f32 v114, v20, v21
    v_cvt_pk_bf16_f32 v115, v22, v23
    v_cvt_pk_bf16_f32 v116, v24, v25
    v_cvt_pk_bf16_f32 v117, v26, v27
    v_cvt_pk_bf16_f32 v118, v28, v29
    v_cvt_pk_bf16_f32 v119, v30, v31
    v_cvt_pk_bf16_f32 v120, v32, v33
    v_cvt_pk_bf16_f32 v121, v34, v35
    v_cvt_pk_bf16_f32 v122, v36, v37
    v_cvt_pk_bf16_f32 v123, v38, v39
    v_cvt_pk_bf16_f32 v124, v40, v41
    v_cvt_pk_bf16_f32 v125, v42, v43
    v_cvt_pk_bf16_f32 v126, v44, v45
    v_cvt_pk_bf16_f32 v127, v46, v47
    v_cvt_pk_bf16_f32 v128, v48, v49
    v_cvt_pk_bf16_f32 v129, v50, v51
    v_cvt_pk_bf16_f32 v130, v52, v53
    v_cvt_pk_bf16_f32 v131, v54, v55
    v_cvt_pk_bf16_f32 v132, v56, v57
    v_cvt_pk_bf16_f32 v133, v58, v59
    v_cvt_pk_bf16_f32 v134, v60, v61
    v_cvt_pk_bf16_f32 v135, v62, v63
    v_cvt_pk_bf16_f32 v136, v64, v65
    v_cvt_pk_bf16_f32 v137, v66, v67
    v_cvt_pk_bf16_f32 v138, v68, v69
    v_cvt_pk_bf16_f32 v139, v70, v71
    v_cvt_pk_bf16_f32 v140, v72, v73
    v_cvt_pk_bf16_f32 v141, v74, v75
    v_cvt_pk_bf16_f32 v142, v76, v77
    v_cvt_pk_bf16_f32 v143, v78, v79
    v_cvt_pk_bf16_f32 v144, v80, v81
    v_cvt_pk_bf16_f32 v145, v82, v83
    v_cvt_pk_bf16_f32 v146, v84, v85
    v_cvt_pk_bf16_f32 v147, v86, v87
    v_cvt_pk_bf16_f32 v148, v88, v89
    v_cvt_pk_bf16_f32 v149, v90, v91
    v_cvt_pk_bf16_f32 v150, v92, v93
    v_cvt_pk_bf16_f32 v151, v94, v95
    v_cvt_pk_bf16_f32 v152, v96, v97
    v_cvt_pk_bf16_f32 v153, v98, v99
    v_cvt_pk_bf16_f32 v154, v100, v101
    v_cvt_pk_bf16_f32 v155, v102, v103
    v_cvt_pk_bf16_f32 v156, v104, v105
    v_cvt_pk_bf16_f32 v157, v106, v107
    v_cvt_pk_bf16_f32 v158, v108, v109
    v_cvt_pk_bf16_f32 v159, v110, v111
    s_waitcnt vmcnt(13)
    v_mfma_f32_16x16x32_bf16 v[16:19], v[148:151], a[0:3], 0
    v_mfma_f32_16x16x32_bf16 v[16:19], v[152:155], a[4:7], v[16:19]
    v_mfma_f32_16x16x32_bf16 v[16:19], v[156:159], a[8:11], v[16:19]
    v_mfma_f32_16x16x32_bf16 v[20:23], v[112:115], a[0:3], 0
    v_mfma_f32_16x16x32_bf16 v[24:27], v[116:119], a[0:3], 0
    v_mfma_f32_16x16x32_bf16 v[24:27], v[120:123], a[4:7], v[24:27]
    v_mfma_f32_16x16x32_bf16 v[28:31], v[124:127], a[0:3], 0
    v_mfma_f32_16x16x32_bf16 v[28:31], v[128:131], a[4:7], v[28:31]
    v_mfma_f32_16x16x32_bf16 v[32:35], v[132:135], a[4:7], 0
    v_mfma_f32_16x16x32_bf16 v[32:35], v[136:139], a[8:11], v[32:35]
    v_mfma_f32_16x16x32_bf16 v[36:39], v[140:143], a[4:7], 0
    v_mfma_f32_16x16x32_bf16 v[36:39], v[144:147], a[8:11], v[36:39]
    s_nop 9
    v_add_f32 v16, 0x358637bd, v16
    v_add_f32 v17, 0x358637bd, v17
    v_add_f32 v18, 0x358637bd, v18
    v_add_f32 v19, 0x358637bd, v19
    v_rcp_f32 v16, v16
    v_rcp_f32 v17, v17
    v_rcp_f32 v18, v18
    v_rcp_f32 v19, v19
    s_nop 1
    v_mov_b32 v2, v16
    v_cndmask_b32 v3, v17, v16, s[40:41]
    v_cndmask_b32 v4, v18, v17, s[42:43]
    v_cndmask_b32 v5, v19, v18, s[44:45]
    v_mov_b32 v6, v19
    v_mul_f32 v20, v20, v2
    v_mul_f32 v21, v21, v2
    v_mul_f32 v22, v22, v2
    v_mul_f32 v23, v23, v2
    v_cvt_pk_bf16_f32 v160, v20, v21
    v_cvt_pk_bf16_f32 v161, v22, v23
    v_mul_f32 v24, v24, v3
    v_mul_f32 v25, v25, v3
    v_mul_f32 v26, v26, v3
    v_mul_f32 v27, v27, v3
    v_cvt_pk_bf16_f32 v162, v24, v25
    v_cvt_pk_bf16_f32 v163, v26, v27
    v_mul_f32 v28, v28, v4
    v_mul_f32 v29, v29, v4
    v_mul_f32 v30, v30, v4
    v_mul_f32 v31, v31, v4
    v_cvt_pk_bf16_f32 v176, v28, v29
    v_cvt_pk_bf16_f32 v177, v30, v31
    v_mul_f32 v32, v32, v5
    v_mul_f32 v33, v33, v5
    v_mul_f32 v34, v34, v5
    v_mul_f32 v35, v35, v5
    v_cvt_pk_bf16_f32 v178, v32, v33
    v_cvt_pk_bf16_f32 v179, v34, v35
    v_mul_f32 v36, v36, v6
    v_mul_f32 v37, v37, v6
    v_mul_f32 v38, v38, v6
    v_mul_f32 v39, v39, v6
    v_cvt_pk_bf16_f32 v192, v36, v37
    v_cvt_pk_bf16_f32 v193, v38, v39
    v_mfma_f32_16x16x32_bf16 v[40:43], v[148:151], a[12:15], 0
    v_mfma_f32_16x16x32_bf16 v[40:43], v[152:155], a[16:19], v[40:43]
    v_mfma_f32_16x16x32_bf16 v[40:43], v[156:159], a[20:23], v[40:43]
    v_mfma_f32_16x16x32_bf16 v[44:47], v[112:115], a[12:15], 0
    v_mfma_f32_16x16x32_bf16 v[48:51], v[116:119], a[12:15], 0
    v_mfma_f32_16x16x32_bf16 v[48:51], v[120:123], a[16:19], v[48:51]
    v_mfma_f32_16x16x32_bf16 v[52:55], v[124:127], a[12:15], 0
    v_mfma_f32_16x16x32_bf16 v[52:55], v[128:131], a[16:19], v[52:55]
    v_mfma_f32_16x16x32_bf16 v[56:59], v[132:135], a[16:19], 0
    v_mfma_f32_16x16x32_bf16 v[56:59], v[136:139], a[20:23], v[56:59]
    v_mfma_f32_16x16x32_bf16 v[60:63], v[140:143], a[16:19], 0
    v_mfma_f32_16x16x32_bf16 v[60:63], v[144:147], a[20:23], v[60:63]
    s_nop 9
    v_add_f32 v40, 0x358637bd, v40
    v_add_f32 v41, 0x358637bd, v41
    v_add_f32 v42, 0x358637bd, v42
    v_add_f32 v43, 0x358637bd, v43
    v_rcp_f32 v40, v40
    v_rcp_f32 v41, v41
    v_rcp_f32 v42, v42
    v_rcp_f32 v43, v43
    s_nop 1
    v_mov_b32 v2, v40
    v_cndmask_b32 v3, v41, v40, s[40:41]
    v_cndmask_b32 v4, v42, v41, s[42:43]
    v_cndmask_b32 v5, v43, v42, s[44:45]
    v_mov_b32 v6, v43
    v_mul_f32 v44, v44, v2
    v_mul_f32 v45, v45, v2
    v_mul_f32 v46, v46, v2
    v_mul_f32 v47, v47, v2
    v_cvt_pk_bf16_f32 v164, v44, v45
    v_cvt_pk_bf16_f32 v165, v46, v47
    v_mul_f32 v48, v48, v3
    v_mul_f32 v49, v49, v3
    v_mul_f32 v50, v50, v3
    v_mul_f32 v51, v51, v3
    v_cvt_pk_bf16_f32 v166, v48, v49
    v_cvt_pk_bf16_f32 v167, v50, v51
    v_mul_f32 v52, v52, v4
    v_mul_f32 v53, v53, v4
    v_mul_f32 v54, v54, v4
    v_mul_f32 v55, v55, v4
    v_cvt_pk_bf16_f32 v180, v52, v53
    v_cvt_pk_bf16_f32 v181, v54, v55
    v_mul_f32 v56, v56, v5
    v_mul_f32 v57, v57, v5
    v_mul_f32 v58, v58, v5
    v_mul_f32 v59, v59, v5
    v_cvt_pk_bf16_f32 v182, v56, v57
    v_cvt_pk_bf16_f32 v183, v58, v59
    v_mul_f32 v60, v60, v6
    v_mul_f32 v61, v61, v6
    v_mul_f32 v62, v62, v6
    v_mul_f32 v63, v63, v6
    v_cvt_pk_bf16_f32 v196, v60, v61
    v_cvt_pk_bf16_f32 v197, v62, v63
    v_mfma_f32_16x16x32_bf16 v[16:19], v[148:151], a[24:27], 0
    v_mfma_f32_16x16x32_bf16 v[16:19], v[152:155], a[28:31], v[16:19]
    v_mfma_f32_16x16x32_bf16 v[16:19], v[156:159], a[32:35], v[16:19]
    v_mfma_f32_16x16x32_bf16 v[20:23], v[112:115], a[24:27], 0
    v_mfma_f32_16x16x32_bf16 v[24:27], v[116:119], a[24:27], 0
    v_mfma_f32_16x16x32_bf16 v[24:27], v[120:123], a[28:31], v[24:27]
    v_mfma_f32_16x16x32_bf16 v[28:31], v[124:127], a[24:27], 0
    v_mfma_f32_16x16x32_bf16 v[28:31], v[128:131], a[28:31], v[28:31]
    v_mfma_f32_16x16x32_bf16 v[32:35], v[132:135], a[28:31], 0
    v_mfma_f32_16x16x32_bf16 v[32:35], v[136:139], a[32:35], v[32:35]
    v_mfma_f32_16x16x32_bf16 v[36:39], v[140:143], a[28:31], 0
    v_mfma_f32_16x16x32_bf16 v[36:39], v[144:147], a[32:35], v[36:39]
    s_nop 9
    v_add_f32 v16, 0x358637bd, v16
    v_add_f32 v17, 0x358637bd, v17
    v_add_f32 v18, 0x358637bd, v18
    v_add_f32 v19, 0x358637bd, v19
    v_rcp_f32 v16, v16
    v_rcp_f32 v17, v17
    v_rcp_f32 v18, v18
    v_rcp_f32 v19, v19
    s_nop 1
    v_mov_b32 v2, v16
    v_cndmask_b32 v3, v17, v16, s[40:41]
    v_cndmask_b32 v4, v18, v17, s[42:43]
    v_cndmask_b32 v5, v19, v18, s[44:45]
    v_mov_b32 v6, v19
    v_mul_f32 v20, v20, v2
    v_mul_f32 v21, v21, v2
    v_mul_f32 v22, v22, v2
    v_mul_f32 v23, v23, v2
    v_cvt_pk_bf16_f32 v168, v20, v21
    v_cvt_pk_bf16_f32 v169, v22, v23
    v_mul_f32 v24, v24, v3
    v_mul_f32 v25, v25, v3
    v_mul_f32 v26, v26, v3
    v_mul_f32 v27, v27, v3
    v_cvt_pk_bf16_f32 v170, v24, v25
    v_cvt_pk_bf16_f32 v171, v26, v27
    v_mul_f32 v28, v28, v4
    v_mul_f32 v29, v29, v4
    v_mul_f32 v30, v30, v4
    v_mul_f32 v31, v31, v4
    v_cvt_pk_bf16_f32 v184, v28, v29
    v_cvt_pk_bf16_f32 v185, v30, v31
    v_mul_f32 v32, v32, v5
    v_mul_f32 v33, v33, v5
    v_mul_f32 v34, v34, v5
    v_mul_f32 v35, v35, v5
    v_cvt_pk_bf16_f32 v186, v32, v33
    v_cvt_pk_bf16_f32 v187, v34, v35
    v_mul_f32 v36, v36, v6
    v_mul_f32 v37, v37, v6
    v_mul_f32 v38, v38, v6
    v_mul_f32 v39, v39, v6
    v_cvt_pk_bf16_f32 v200, v36, v37
    v_cvt_pk_bf16_f32 v201, v38, v39
    v_mfma_f32_16x16x32_bf16 v[40:43], v[148:151], a[36:39], 0
    v_mfma_f32_16x16x32_bf16 v[40:43], v[152:155], a[40:43], v[40:43]
    v_mfma_f32_16x16x32_bf16 v[40:43], v[156:159], a[44:47], v[40:43]
    v_mfma_f32_16x16x32_bf16 v[44:47], v[112:115], a[36:39], 0
    v_mfma_f32_16x16x32_bf16 v[48:51], v[116:119], a[36:39], 0
    v_mfma_f32_16x16x32_bf16 v[48:51], v[120:123], a[40:43], v[48:51]
    v_mfma_f32_16x16x32_bf16 v[52:55], v[124:127], a[36:39], 0
    v_mfma_f32_16x16x32_bf16 v[52:55], v[128:131], a[40:43], v[52:55]
    v_mfma_f32_16x16x32_bf16 v[56:59], v[132:135], a[40:43], 0
    v_mfma_f32_16x16x32_bf16 v[56:59], v[136:139], a[44:47], v[56:59]
    v_mfma_f32_16x16x32_bf16 v[60:63], v[140:143], a[40:43], 0
    v_mfma_f32_16x16x32_bf16 v[60:63], v[144:147], a[44:47], v[60:63]
    s_nop 9
    v_add_f32 v40, 0x358637bd, v40
    v_add_f32 v41, 0x358637bd, v41
    v_add_f32 v42, 0x358637bd, v42
    v_add_f32 v43, 0x358637bd, v43
    v_rcp_f32 v40, v40
    v_rcp_f32 v41, v41
    v_rcp_f32 v42, v42
    v_rcp_f32 v43, v43
    s_nop 1
    v_mov_b32 v2, v40
    v_cndmask_b32 v3, v41, v40, s[40:41]
    v_cndmask_b32 v4, v42, v41, s[42:43]
    v_cndmask_b32 v5, v43, v42, s[44:45]
    v_mov_b32 v6, v43
    v_mul_f32 v44, v44, v2
    v_mul_f32 v45, v45, v2
    v_mul_f32 v46, v46, v2
    v_mul_f32 v47, v47, v2
    v_cvt_pk_bf16_f32 v172, v44, v45
    v_cvt_pk_bf16_f32 v173, v46, v47
    v_mul_f32 v48, v48, v3
    v_mul_f32 v49, v49, v3
    v_mul_f32 v50, v50, v3
    v_mul_f32 v51, v51, v3
    v_cvt_pk_bf16_f32 v174, v48, v49
    v_cvt_pk_bf16_f32 v175, v50, v51
    v_mul_f32 v52, v52, v4
    v_mul_f32 v53, v53, v4
    v_mul_f32 v54, v54, v4
    v_mul_f32 v55, v55, v4
    v_cvt_pk_bf16_f32 v188, v52, v53
    v_cvt_pk_bf16_f32 v189, v54, v55
    v_mul_f32 v56, v56, v5
    v_mul_f32 v57, v57, v5
    v_mul_f32 v58, v58, v5
    v_mul_f32 v59, v59, v5
    v_cvt_pk_bf16_f32 v190, v56, v57
    v_cvt_pk_bf16_f32 v191, v58, v59
    v_mul_f32 v60, v60, v6
    v_mul_f32 v61, v61, v6
    v_mul_f32 v62, v62, v6
    v_mul_f32 v63, v63, v6
    v_cvt_pk_bf16_f32 v204, v60, v61
    v_cvt_pk_bf16_f32 v205, v62, v63
    v_lshrrev_b32 v12, 2, v10
    v_lshl_add_u32 v12, v11, 2, v12
    v_mul_u32_u24 v2, 160, v12
    v_and_b32 v12, 3, v1
    v_lshl_add_u32 v2, v12, 3, v2
    v_add_u32 v2, s35, v2
    s_waitcnt vmcnt(0)
    ds_read_b64_tr_b16 v[96:97], v2 offset:0
    ds_read_b64_tr_b16 v[98:99], v2 offset:2560
    ds_read_b64_tr_b16 v[100:101], v2 offset:32
    ds_read_b64_tr_b16 v[102:103], v2 offset:2592
    ds_read_b64_tr_b16 v[104:105], v2 offset:64
    ds_read_b64_tr_b16 v[106:107], v2 offset:2624
    ds_read_b64_tr_b16 v[108:109], v2 offset:96
    ds_read_b64_tr_b16 v[110:111], v2 offset:2656
    ds_read_b64_tr_b16 v[112:113], v2 offset:128
    ds_read_b64_tr_b16 v[114:115], v2 offset:2688
    ds_read_b64_tr_b16 v[116:117], v2 offset:5120
    ds_read_b64_tr_b16 v[118:119], v2 offset:7680
    ds_read_b64_tr_b16 v[120:121], v2 offset:5152
    ds_read_b64_tr_b16 v[122:123], v2 offset:7712
    ds_read_b64_tr_b16 v[124:125], v2 offset:5184
    ds_read_b64_tr_b16 v[126:127], v2 offset:7744
    ds_read_b64_tr_b16 v[128:129], v2 offset:5216
    ds_read_b64_tr_b16 v[130:131], v2 offset:7776
    ds_read_b64_tr_b16 v[132:133], v2 offset:5248
    ds_read_b64_tr_b16 v[134:135], v2 offset:7808
    ds_read_b64_tr_b16 v[136:137], v2 offset:10240
    ds_read_b64_tr_b16 v[138:139], v2 offset:10240
    ds_read_b64_tr_b16 v[140:141], v2 offset:10272
    ds_read_b64_tr_b16 v[142:143], v2 offset:10272
    ds_read_b64_tr_b16 v[144:145], v2 offset:10304
    ds_read_b64_tr_b16 v[146:147], v2 offset:10304
    ds_read_b64_tr_b16 v[148:149], v2 offset:10336
    ds_read_b64_tr_b16 v[150:151], v2 offset:10336
    ds_read_b64_tr_b16 v[152:153], v2 offset:10368
    ds_read_b64_tr_b16 v[154:155], v2 offset:10368
    s_waitcnt lgkmcnt(10)
    v_mfma_f32_16x16x32_bf16 v[16:19], v[96:99], v[160:163], 0
    v_mfma_f32_16x16x32_bf16 v[20:23], v[96:99], v[164:167], 0
    v_mfma_f32_16x16x32_bf16 v[24:27], v[96:99], v[168:171], 0
    v_mfma_f32_16x16x32_bf16 v[28:31], v[96:99], v[172:175], 0
    v_mfma_f32_16x16x32_bf16 v[32:35], v[100:103], v[160:163], 0
    v_mfma_f32_16x16x32_bf16 v[36:39], v[100:103], v[164:167], 0
    v_mfma_f32_16x16x32_bf16 v[40:43], v[100:103], v[168:171], 0
    v_mfma_f32_16x16x32_bf16 v[44:47], v[100:103], v[172:175], 0
    v_mfma_f32_16x16x32_bf16 v[48:51], v[104:107], v[160:163], 0
    v_mfma_f32_16x16x32_bf16 v[52:55], v[104:107], v[164:167], 0
    v_mfma_f32_16x16x32_bf16 v[56:59], v[104:107], v[168:171], 0
    v_mfma_f32_16x16x32_bf16 v[60:63], v[104:107], v[172:175], 0
    v_mfma_f32_16x16x32_bf16 v[64:67], v[108:111], v[160:163], 0
    v_mfma_f32_16x16x32_bf16 v[68:71], v[108:111], v[164:167], 0
    v_mfma_f32_16x16x32_bf16 v[72:75], v[108:111], v[168:171], 0
    v_mfma_f32_16x16x32_bf16 v[76:79], v[108:111], v[172:175], 0
    v_mfma_f32_16x16x32_bf16 v[80:83], v[112:115], v[160:163], 0
    v_mfma_f32_16x16x32_bf16 v[84:87], v[112:115], v[164:167], 0
    v_mfma_f32_16x16x32_bf16 v[88:91], v[112:115], v[168:171], 0
    v_mfma_f32_16x16x32_bf16 v[92:95], v[112:115], v[172:175], 0
    s_waitcnt lgkmcnt(10)
    v_mfma_f32_16x16x32_bf16 v[16:19], v[116:119], v[176:179], v[16:19]
    v_mfma_f32_16x16x32_bf16 v[20:23], v[116:119], v[180:183], v[20:23]
    v_mfma_f32_16x16x32_bf16 v[24:27], v[116:119], v[184:187], v[24:27]
    v_mfma_f32_16x16x32_bf16 v[28:31], v[116:119], v[188:191], v[28:31]
    v_mfma_f32_16x16x32_bf16 v[32:35], v[120:123], v[176:179], v[32:35]
    v_mfma_f32_16x16x32_bf16 v[36:39], v[120:123], v[180:183], v[36:39]
    v_mfma_f32_16x16x32_bf16 v[40:43], v[120:123], v[184:187], v[40:43]
    v_mfma_f32_16x16x32_bf16 v[44:47], v[120:123], v[188:191], v[44:47]
    v_mfma_f32_16x16x32_bf16 v[48:51], v[124:127], v[176:179], v[48:51]
    v_mfma_f32_16x16x32_bf16 v[52:55], v[124:127], v[180:183], v[52:55]
    v_mfma_f32_16x16x32_bf16 v[56:59], v[124:127], v[184:187], v[56:59]
    v_mfma_f32_16x16x32_bf16 v[60:63], v[124:127], v[188:191], v[60:63]
    v_mfma_f32_16x16x32_bf16 v[64:67], v[128:131], v[176:179], v[64:67]
    v_mfma_f32_16x16x32_bf16 v[68:71], v[128:131], v[180:183], v[68:71]
    v_mfma_f32_16x16x32_bf16 v[72:75], v[128:131], v[184:187], v[72:75]
    v_mfma_f32_16x16x32_bf16 v[76:79], v[128:131], v[188:191], v[76:79]
    v_mfma_f32_16x16x32_bf16 v[80:83], v[132:135], v[176:179], v[80:83]
    v_mfma_f32_16x16x32_bf16 v[84:87], v[132:135], v[180:183], v[84:87]
    v_mfma_f32_16x16x32_bf16 v[88:91], v[132:135], v[184:187], v[88:91]
    v_mfma_f32_16x16x32_bf16 v[92:95], v[132:135], v[188:191], v[92:95]
    s_waitcnt lgkmcnt(0)
    v_mfma_f32_16x16x32_bf16 v[16:19], v[136:139], v[192:195], v[16:19]
    v_mfma_f32_16x16x32_bf16 v[20:23], v[136:139], v[196:199], v[20:23]
    v_mfma_f32_16x16x32_bf16 v[24:27], v[136:139], v[200:203], v[24:27]
    v_mfma_f32_16x16x32_bf16 v[28:31], v[136:139], v[204:207], v[28:31]
    v_mfma_f32_16x16x32_bf16 v[32:35], v[140:143], v[192:195], v[32:35]
    v_mfma_f32_16x16x32_bf16 v[36:39], v[140:143], v[196:199], v[36:39]
    v_mfma_f32_16x16x32_bf16 v[40:43], v[140:143], v[200:203], v[40:43]
    v_mfma_f32_16x16x32_bf16 v[44:47], v[140:143], v[204:207], v[44:47]
    v_mfma_f32_16x16x32_bf16 v[48:51], v[144:147], v[192:195], v[48:51]
    v_mfma_f32_16x16x32_bf16 v[52:55], v[144:147], v[196:199], v[52:55]
    v_mfma_f32_16x16x32_bf16 v[56:59], v[144:147], v[200:203], v[56:59]
    v_mfma_f32_16x16x32_bf16 v[60:63], v[144:147], v[204:207], v[60:63]
    v_mfma_f32_16x16x32_bf16 v[64:67], v[148:151], v[192:195], v[64:67]
    v_mfma_f32_16x16x32_bf16 v[68:71], v[148:151], v[196:199], v[68:71]
    v_mfma_f32_16x16x32_bf16 v[72:75], v[148:151], v[200:203], v[72:75]
    v_mfma_f32_16x16x32_bf16 v[76:79], v[148:151], v[204:207], v[76:79]
    v_mfma_f32_16x16x32_bf16 v[80:83], v[152:155], v[192:195], v[80:83]
    v_mfma_f32_16x16x32_bf16 v[84:87], v[152:155], v[196:199], v[84:87]
    v_mfma_f32_16x16x32_bf16 v[88:91], v[152:155], v[200:203], v[88:91]
    v_mfma_f32_16x16x32_bf16 v[92:95], v[152:155], v[204:207], v[92:95]
    s_nop 9
    s_barrier
    v_lshlrev_b32 v3, 4, v1
    s_mul_i32 s33, s28, 20480
    v_add_u32 v4, s33, v3
    ds_write_b128 v4, v[16:19] offset:0
    ds_write_b128 v4, v[20:23] offset:1024
    ds_write_b128 v4, v[24:27] offset:2048
    ds_write_b128 v4, v[28:31] offset:3072
    ds_write_b128 v4, v[32:35] offset:4096
    ds_write_b128 v4, v[36:39] offset:5120
    ds_write_b128 v4, v[40:43] offset:6144
    ds_write_b128 v4, v[44:47] offset:7168
    ds_write_b128 v4, v[48:51] offset:8192
    ds_write_b128 v4, v[52:55] offset:9216
    ds_write_b128 v4, v[56:59] offset:10240
    ds_write_b128 v4, v[60:63] offset:11264
    ds_write_b128 v4, v[64:67] offset:12288
    ds_write_b128 v4, v[68:71] offset:13312
    ds_write_b128 v4, v[72:75] offset:14336
    ds_write_b128 v4, v[76:79] offset:15360
    ds_write_b128 v4, v[80:83] offset:16384
    ds_write_b128 v4, v[84:87] offset:17408
    ds_write_b128 v4, v[88:91] offset:18432
    ds_write_b128 v4, v[92:95] offset:19456
    s_waitcnt lgkmcnt(0)
    s_barrier
    s_lshl_b32 s33, s28, 10
    v_add_u32 v4, s33, v3
    v_add_u32 v5, 61440, v4
    v_add_u32 v6, 61440, v5
    ds_read_b128 v[16:19], v4 offset:0
    ds_read_b128 v[20:23], v4 offset:20480
    ds_read_b128 v[24:27], v4 offset:40960
    ds_read_b128 v[28:31], v5 offset:0
    ds_read_b128 v[32:35], v5 offset:20480
    ds_read_b128 v[36:39], v5 offset:40960
    ds_read_b128 v[40:43], v6 offset:0
    ds_read_b128 v[44:47], v6 offset:20480
    s_add_u32 s33, s28, 0
    s_lshr_b32 s34, s33, 2
    s_and_b32 s35, s33, 3
    s_lshl_b32 s36, s29, 6
    s_lshl_b32 s37, s35, 4
    s_add_u32 s36, s36, s37
    v_add_u32 v50, s36, v10
    v_mul_u32_u24 v50, 1280, v50
    v_lshl_add_u32 v50, v11, 3, v50
    s_mul_i32 s36, s30, 160
    s_lshl_b32 s37, s34, 5
    s_add_u32 s36, s36, s37
    s_waitcnt lgkmcnt(0)
    v_add_f32 v16, v16, v20
    v_add_f32 v16, v16, v24
    v_add_f32 v16, v16, v28
    v_add_f32 v16, v16, v32
    v_add_f32 v16, v16, v36
    v_add_f32 v16, v16, v40
    v_add_f32 v16, v16, v44
    v_add_f32 v17, v17, v21
    v_add_f32 v17, v17, v25
    v_add_f32 v17, v17, v29
    v_add_f32 v17, v17, v33
    v_add_f32 v17, v17, v37
    v_add_f32 v17, v17, v41
    v_add_f32 v17, v17, v45
    v_add_f32 v18, v18, v22
    v_add_f32 v18, v18, v26
    v_add_f32 v18, v18, v30
    v_add_f32 v18, v18, v34
    v_add_f32 v18, v18, v38
    v_add_f32 v18, v18, v42
    v_add_f32 v18, v18, v46
    v_add_f32 v19, v19, v23
    v_add_f32 v19, v19, v27
    v_add_f32 v19, v19, v31
    v_add_f32 v19, v19, v35
    v_add_f32 v19, v19, v39
    v_add_f32 v19, v19, v43
    v_add_f32 v19, v19, v47
    v_cvt_pk_bf16_f32 v48, v16, v17
    v_cvt_pk_bf16_f32 v49, v18, v19
    buffer_store_dwordx2 v[48:49], v50, s[12:15], s36 offen
    s_nop 1
    ds_read_b128 v[16:19], v4 offset:8192
    ds_read_b128 v[20:23], v4 offset:28672
    ds_read_b128 v[24:27], v4 offset:49152
    ds_read_b128 v[28:31], v5 offset:8192
    ds_read_b128 v[32:35], v5 offset:28672
    ds_read_b128 v[36:39], v5 offset:49152
    ds_read_b128 v[40:43], v6 offset:8192
    ds_read_b128 v[44:47], v6 offset:28672
    s_add_u32 s33, s28, 8
    s_lshr_b32 s34, s33, 2
    s_and_b32 s35, s33, 3
    s_lshl_b32 s36, s29, 6
    s_lshl_b32 s37, s35, 4
    s_add_u32 s36, s36, s37
    v_add_u32 v50, s36, v10
    v_mul_u32_u24 v50, 1280, v50
    v_lshl_add_u32 v50, v11, 3, v50
    s_mul_i32 s36, s30, 160
    s_lshl_b32 s37, s34, 5
    s_add_u32 s36, s36, s37
    s_waitcnt lgkmcnt(0)
    v_add_f32 v16, v16, v20
    v_add_f32 v16, v16, v24
    v_add_f32 v16, v16, v28
    v_add_f32 v16, v16, v32
    v_add_f32 v16, v16, v36
    v_add_f32 v16, v16, v40
    v_add_f32 v16, v16, v44
    v_add_f32 v17, v17, v21
    v_add_f32 v17, v17, v25
    v_add_f32 v17, v17, v29
    v_add_f32 v17, v17, v33
    v_add_f32 v17, v17, v37
    v_add_f32 v17, v17, v41
    v_add_f32 v17, v17, v45
    v_add_f32 v18, v18, v22
    v_add_f32 v18, v18, v26
    v_add_f32 v18, v18, v30
    v_add_f32 v18, v18, v34
    v_add_f32 v18, v18, v38
    v_add_f32 v18, v18, v42
    v_add_f32 v18, v18, v46
    v_add_f32 v19, v19, v23
    v_add_f32 v19, v19, v27
    v_add_f32 v19, v19, v31
    v_add_f32 v19, v19, v35
    v_add_f32 v19, v19, v39
    v_add_f32 v19, v19, v43
    v_add_f32 v19, v19, v47
    v_cvt_pk_bf16_f32 v48, v16, v17
    v_cvt_pk_bf16_f32 v49, v18, v19
    buffer_store_dwordx2 v[48:49], v50, s[12:15], s36 offen
    s_nop 1
    s_cmp_ge_u32 s28, 4
    s_cbranch_scc1 K2_FIN
    ds_read_b128 v[16:19], v4 offset:16384
    ds_read_b128 v[20:23], v4 offset:36864
    ds_read_b128 v[24:27], v4 offset:57344
    ds_read_b128 v[28:31], v5 offset:16384
    ds_read_b128 v[32:35], v5 offset:36864
    ds_read_b128 v[36:39], v5 offset:57344
    ds_read_b128 v[40:43], v6 offset:16384
    ds_read_b128 v[44:47], v6 offset:36864
    s_add_u32 s33, s28, 16
    s_lshr_b32 s34, s33, 2
    s_and_b32 s35, s33, 3
    s_lshl_b32 s36, s29, 6
    s_lshl_b32 s37, s35, 4
    s_add_u32 s36, s36, s37
    v_add_u32 v50, s36, v10
    v_mul_u32_u24 v50, 1280, v50
    v_lshl_add_u32 v50, v11, 3, v50
    s_mul_i32 s36, s30, 160
    s_lshl_b32 s37, s34, 5
    s_add_u32 s36, s36, s37
    s_waitcnt lgkmcnt(0)
    v_add_f32 v16, v16, v20
    v_add_f32 v16, v16, v24
    v_add_f32 v16, v16, v28
    v_add_f32 v16, v16, v32
    v_add_f32 v16, v16, v36
    v_add_f32 v16, v16, v40
    v_add_f32 v16, v16, v44
    v_add_f32 v17, v17, v21
    v_add_f32 v17, v17, v25
    v_add_f32 v17, v17, v29
    v_add_f32 v17, v17, v33
    v_add_f32 v17, v17, v37
    v_add_f32 v17, v17, v41
    v_add_f32 v17, v17, v45
    v_add_f32 v18, v18, v22
    v_add_f32 v18, v18, v26
    v_add_f32 v18, v18, v30
    v_add_f32 v18, v18, v34
    v_add_f32 v18, v18, v38
    v_add_f32 v18, v18, v42
    v_add_f32 v18, v18, v46
    v_add_f32 v19, v19, v23
    v_add_f32 v19, v19, v27
    v_add_f32 v19, v19, v31
    v_add_f32 v19, v19, v35
    v_add_f32 v19, v19, v39
    v_add_f32 v19, v19, v43
    v_add_f32 v19, v19, v47
    v_cvt_pk_bf16_f32 v48, v16, v17
    v_cvt_pk_bf16_f32 v49, v18, v19
    buffer_store_dwordx2 v[48:49], v50, s[12:15], s36 offen
    s_nop 1
K2_FIN:
    s_waitcnt vmcnt(0)
K2_END:
    s_endpgm
.section .rodata,"a"
.p2align 6
.amdhsa_kernel standalone__linear_attn_block__prompt_kernel
  .amdhsa_next_free_vgpr 256
  .amdhsa_next_free_sgpr 96
  .amdhsa_accum_offset 176
  .amdhsa_group_segment_fixed_size 0
  .amdhsa_kernarg_size 48
  .amdhsa_user_sgpr_count 2
  .amdhsa_user_sgpr_kernarg_segment_ptr 1
  .amdhsa_system_sgpr_workgroup_id_x 1
.end_amdhsa_kernel
.amdhsa_kernel linear_attn_out_kernel
  .amdhsa_next_free_vgpr 256
  .amdhsa_next_free_sgpr 96
  .amdhsa_accum_offset 208
  .amdhsa_group_segment_fixed_size 0
  .amdhsa_kernarg_size 48
  .amdhsa_user_sgpr_count 2
  .amdhsa_user_sgpr_kernarg_segment_ptr 1
  .amdhsa_system_sgpr_workgroup_id_x 1
.end_amdhsa_kernel
```
